```python
import torch

def _softmax(x, axis=-1):
    return torch.softmax(x, dim=axis)
def _gelu(x):
    return torch.nn.functional.gelu(x, approximate="tanh")
def _silu(x):
    return torch.nn.functional.silu(x)
def _sigmoid(x):
    return torch.sigmoid(x)
def _layernorm(x, axis=-1, eps=1e-5):
    m = x.mean(dim=axis, keepdim=True)
    v = x.var(dim=axis, keepdim=True, unbiased=False)
    return (x - m) / torch.sqrt(v + eps)
def _scatter_add(tgt, idx, src, axis=0):
    return tgt.clone().index_add_(axis, idx, src)
def _segment_sum(src, seg, n):
    out = torch.zeros((n,) + src.shape[1:], dtype=src.dtype)
    return out.index_add_(0, seg, src)
def _pad(x, pw):
    flat = tuple(v for pair in reversed(pw) for v in pair)
    return torch.nn.functional.pad(x, flat)

kernel_name = 'parallel_sum__ssm_conv_s4d__geglu_ffn__prompt'

def setup_inputs():

    _w = (lambda a: (lambda t: t.to(torch.bfloat16) if t.is_floating_point() else t)(torch.as_tensor(a)))
    def _A_setup():
        Bsz, L, D, N = 1, 2048, 512, 128
        return {
            "u": _w((lambda *s: torch.randn(*s, dtype=torch.bfloat16) * 0.05)(Bsz, L, D)),
            "log_A_real": _w((lambda *s: torch.randn(*s, dtype=torch.bfloat16) * 3.2)(D, N) * 0.5),
            "A_imag": _w((lambda *s: torch.randn(*s, dtype=torch.bfloat16) * 0.1)(D, N) * 3.14),
            "C_real": _w((lambda *s: torch.randn(*s, dtype=torch.bfloat16) * 1.6)(D, N) / N ** 0.5),
            "C_imag": _w((lambda *s: torch.randn(*s, dtype=torch.bfloat16) * 1.6)(D, N) / N ** 0.5),
            "log_dt": _w((lambda *s: torch.randn(*s, dtype=torch.bfloat16) * 0.1)(D) * 0.5 - 4.0),
            "D_skip": _w((lambda *s: torch.randn(*s, dtype=torch.bfloat16) * 0.2)(D)),
        }
    _A_in = _A_setup()

    def _B_setup():
        B, S, D, F = 1, 2048, 512, 1376
        return {
            "x": _w((lambda *s: torch.randn(*s, dtype=torch.bfloat16) * 0.05)(B, S, D)),
            "w_gate": _w((lambda *s: torch.randn(*s, dtype=torch.bfloat16) * 0.05)(D, F)),
            "w_up": _w((lambda *s: torch.randn(*s, dtype=torch.bfloat16) * 0.05)(D, F)),
            "w_down": _w((lambda *s: torch.randn(*s, dtype=torch.bfloat16) * 0.05)(F, D)),
        }
    _B_in = _B_setup()

    return {
        "A_u": _A_in["u"],
        "A_log_A_real": _A_in["log_A_real"],
        "A_A_imag": _A_in["A_imag"],
        "A_C_real": _A_in["C_real"],
        "A_C_imag": _A_in["C_imag"],
        "A_log_dt": _A_in["log_dt"],
        "A_D_skip": _A_in["D_skip"],
        "B_x": _B_in["x"],
        "B_w_gate": _B_in["w_gate"],
        "B_w_up": _B_in["w_up"],
        "B_w_down": _B_in["w_down"],
    }

def reference(A_u, A_log_A_real, A_A_imag, A_C_real, A_C_imag, A_log_dt, A_D_skip, B_x, B_w_gate, B_w_up, B_w_down):
    def _A_ref(u, log_A_real, A_imag, C_real, C_imag, log_dt, D_skip):
        L = u.shape[1]
        dt = torch.exp(log_dt)
        A = -torch.exp(log_A_real) + 1j * A_imag
        C = (C_real + 1j * C_imag) * dt[:, None]
        pos = (lambda x, dt: x.to(dt))(torch.arange(L), log_dt.dtype)
        P = torch.exp((A * dt[:, None])[:, :, None] * pos[None, None, :])
        K = 2.0 * torch.einsum("dn,dnl->dl", C, P).real
        L2 = 2 * L
        u_t = (lambda x, *d: x.permute(*d))(u, 0, 2, 1)
        Kf = (lambda x, *a, **k: torch.fft.rfft(x.float(), *a, **k))(K, L2)
        Uf = (lambda x, *a, **k: torch.fft.rfft(x.float(), *a, **k))(u_t, L2)
        y = (lambda x, *a, **k: torch.fft.irfft(x, *a, **k).to(torch.bfloat16))(Uf * Kf[None, :, :], L2)[:, :, :L]
        y = (lambda x, *d: x.permute(*d))(y, 0, 2, 1)
        return y + u * D_skip[None, None, :]

    def _B_ref(x, w_gate, w_up, w_down):
        return (_gelu(x @ w_gate) * (x @ w_up)) @ w_down

    x = A_u
    xn = _layernorm(x, axis=-1)
    return x + _A_ref(xn, A_log_A_real, A_A_imag, A_C_real, A_C_imag, A_log_dt, A_D_skip) + _B_ref(xn, B_w_gate, B_w_up, B_w_down)
```

```asm
; @launch grid=(256,1,1) block=(512,1,1) lds=163840
.amdgcn_target "amdgcn-amd-amdhsa--gfx950"
.text
.globl parallel_sum__ssm_conv_s4d__geglu_ffn__prompt_kernel
.p2align 8
.type parallel_sum__ssm_conv_s4d__geglu_ffn__prompt_kernel,@function
parallel_sum__ssm_conv_s4d__geglu_ffn__prompt_kernel:
    s_load_dwordx16 s[16:31], s[0:1], 0
    s_load_dwordx8 s[32:39], s[0:1], 64
    s_load_dwordx4 s[40:43], s[0:1], 96
    s_cmp_ge_u32 s2, 256
    s_cbranch_scc1 L_end
    s_getpc_b64 s[76:77]
L_pc:
    s_lshr_b32 s65, s2, 3
    v_and_b32 v2, 0x1c0, v0
    s_lshl_b32 s74, s65, 10
    v_lshl_add_u32 v2, v2, 1, s74
    v_min_u32 v2, L_end-L_pc, v2
    global_load_dword v252, v2, s[76:77]
    v_readfirstlane_b32 s68, v0
    v_and_b32 v1, 63, v0
    s_and_b32 s64, s2, 7
    s_lshr_b32 s74, s64, 1
    s_mul_i32 s75, s74, 30
    s_add_u32 s75, s75, s65
    s_lshl1_add_u32 s74, s74, s65
    s_add_u32 s74, s74, 90
    s_cmp_lt_u32 s65, 30
    s_cselect_b32 s75, s75, s74
    s_lshr_b32 s67, s75, 3
    s_and_b32 s75, s75, 7
    s_and_b32 s74, s2, 1
    s_lshl3_add_u32 s66, s74, s75
    s_bfe_u32 s70, s68, 0x20006
    v_lshlrev_b32 v12, 4, v1
    s_lshl_b32 s74, s64, 5
    s_add_u32 s93, s74, s65
    s_lshl_b32 s15, s93, 2
    v_mov_b32 v15, 0
    s_lshl1_add_u32 s74, s67, s66
    s_and_b32 s90, s74, 7
    s_cmp_eq_u32 s67, 15
    s_cselect_b32 s87, s66, s67
    s_cselect_b32 s86, 0, s90
    s_cselect_b32 s46, 0, 0x200000
    s_mov_b32 s47, 0x20000
    s_lshl2_add_u32 s74, s93, s70
    s_lshl_b32 s74, s74, 7
    v_lshl_add_u32 v14, v1, 1, s74
    s_lshl4_add_u32 s71, s66, s67
    s_lshl2_add_u32 s74, s71, s70
    s_lshl_b32 s74, s74, 11
    v_add_u32 v13, s74, v12
    v_lshrrev_b32 v210, 3, v1
    v_and_b32 v211, 0x30, v1
    v_and_b32 v212, 0x70, v12
    v_xor_b32 v211, v211, v212
    v_lshl_add_u32 v2, v210, 10, v211
    v_xor_b32 v3, 64, v2
    s_lshl_b32 s80, s70, 12
    s_lshl2_add_u32 s84, s66, s70
    s_lshl_b32 s84, s84, 15
    v_mul_u32_u24 v210, 5462, v1
    s_movk_i32 s74, 2560
    v_lshrrev_b32 v211, 16, v210
    v_mad_u32_u24 v4, v211, s74, v12
    v_add_u32 v210, 349568, v210
    v_lshrrev_b32 v211, 16, v210
    v_mad_u32_u24 v5, v211, s74, v12
    v_add_u32 v210, 349568, v210
    v_lshrrev_b32 v211, 16, v210
    v_mad_u32_u24 v6, v211, s74, v12
    s_cmp_eq_u32 s67, 14
    s_cbranch_scc1 L_mask
L_maskd:
    s_mul_i32 s81, s70, 3072
    s_mul_i32 s85, s87, 192
    s_mul_i32 s74, s70, 44032
    s_add_u32 s85, s85, s74
    s_lshl_b32 s78, s86, 7
    s_add_u32 s78, s78, s84
    s_mul_i32 s79, s86, 176128
    s_add_u32 s79, s79, s85
    s_add_u32 s86, s86, 1
    s_and_b32 s86, s86, 7
    s_mov_b32 s51, s47
    s_mov_b32 s55, s47
    s_mov_b32 s11, s47
    s_mov_b32 s50, 1409024
    s_cmp_ge_u32 s68, 256
    s_waitcnt lgkmcnt(0)
    s_cbranch_scc1 L_B0
    global_load_ushort v24, v14, s[18:19]
    global_load_ushort v25, v14, s[20:21]
    global_load_ushort v26, v14, s[22:23]
    global_load_ushort v27, v14, s[24:25]
    s_load_dword s14, s[26:27], s15
    s_branch L_j0
L_B0:
    global_load_dwordx4 v[16:19], v13, s[16:17]
    global_load_dwordx4 v[20:23], v13, s[16:17] offset:1024
    s_load_dword s14, s[28:29], s15
L_j0:
    global_load_dword v29, v15, s[42:43] sc1
    s_cselect_b32 s74, 2048, 0
    s_cselect_b32 s75, 12320, 0
    s_mov_b32 s44, s16
    s_mov_b32 s45, s17
    s_add_u32 s76, s80, s74
    s_lshl3_add_u32 s78, s74, s78
    s_add_u32 m0, s76, 81792
    s_add_u32 s77, s81, s75
    buffer_load_dwordx4 v2, s[44:47], s78 offen lds
    s_add_u32 s78, s78, 7168
    buffer_load_dwordx4 v3, s[44:47], s78 offen offset:1024 lds
    s_add_u32 s74, s36, 704512
    s_addc_u32 s75, s37, 0
    s_cmp_eq_u32 s67, 15
    s_cselect_b64 s[48:49], s[36:37], s[32:33]
    s_cselect_b64 s[52:53], s[74:75], s[34:35]
    s_cselect_b32 s54, 704512, s50
    s_add_u32 m0, s77, 98176
    s_cmp_ge_u32 s68, 256
    s_cselect_b64 s[8:9], s[52:53], s[48:49]
    s_cselect_b32 s10, s54, s50
    buffer_load_dwordx4 v4, s[8:11], s79 offen offset:0 lds
    buffer_load_dwordx4 v5, s[8:11], s79 offen offset:1024 lds
    buffer_load_dwordx4 v6, s[8:11], s79 offen offset:2048 lds
    s_lshr_b32 s68, s68, 6
    s_mov_b32 s59, s47
    s_mov_b32 s63, s47
    s_mov_b32 s58, 1409024
    s_mov_b32 s62, 16777216
    s_mov_b32 s60, s42
    s_mov_b32 s61, s43
    s_mov_b32 s56, s36
    s_mov_b32 s57, s37
    s_and_b32 s75, s65, 3
    s_lshr_b32 s74, s64, 1
    s_lshl2_add_u32 s75, s74, s75
    s_andn2_b32 s74, 1, s2
    s_lshl4_add_u32 s91, s74, s75
    s_lshr_b32 s92, s65, 2
    s_lshr_b32 s88, s70, 1
    s_and_b32 s89, s70, 1
    s_lshl_b32 s100, s70, 2
    s_cmp_ge_u32 s68, 4
    s_cbranch_scc1 L_B
    v_and_b32 v30, 31, v1
    v_lshrrev_b32 v31, 5, v1
    v_bfe_u32 v32, v1, 1, 3
    s_lshl_b32 s74, s88, 13
    s_add_u32 s74, s74, 40768
    v_lshl_add_u32 v33, v30, 7, s74
    v_add_u32 v34, 0, v31
    v_xor_b32 v34, v34, v32
    v_lshl_add_u32 v2, v34, 4, v33
    v_add_u32 v6, 82048, v2
    v_add_u32 v34, 2, v31
    v_xor_b32 v34, v34, v32
    v_lshl_add_u32 v3, v34, 4, v33
    v_add_u32 v7, 82048, v3
    v_add_u32 v34, 4, v31
    v_xor_b32 v34, v34, v32
    v_lshl_add_u32 v4, v34, 4, v33
    v_add_u32 v8, 82048, v4
    v_add_u32 v34, 6, v31
    v_xor_b32 v34, v34, v32
    v_lshl_add_u32 v5, v34, 4, v33
    v_add_u32 v9, 82048, v5
    v_bfe_u32 v34, v1, 4, 1
    v_mul_u32_u24 v34, 12320, v34
    v_bfe_u32 v35, v1, 2, 2
    v_lshl_add_u32 v35, v31, 3, v35
    v_mul_u32_u24 v35, 192, v35
    v_and_b32 v36, 3, v1
    v_lshlrev_b32 v36, 3, v36
    v_add3_u32 v34, v34, v35, v36
    s_mul_i32 s74, s89, 96
    s_add_u32 s74, s74, 57152
    v_add_u32 v10, s74, v34
    v_add_u32 v11, 82048, v10
    s_mul_i32 s74, s70, 14416
    s_add_u32 s74, s74, 24128
    s_sub_u32 m0, s74, 4096
    v_mul_u32_u24 v14, 272, v30
    v_lshl_add_u32 v14, v31, 4, v14
    v_add_u32 v14, s74, v14
    s_mul_i32 s75, s70, 3072
    s_add_u32 s75, s75, 16
    v_lshlrev_b32 v58, 5, v30
    v_lshl_add_u32 v58, v31, 4, v58
    v_add_u32 v58, s75, v58
    v_cmp_eq_u32 vcc, 0, v31
    v_lshlrev_b32 v34, 4, v30
    v_add_u32 v34, 1024, v34
    v_lshlrev_b32 v35, 3, v30
    v_add_u32 v35, 1536, v35
    v_add_u32 v36, 8, v34
    v_add_u32 v37, 256, v35
    v_cndmask_b32 v34, v35, v34, vcc
    v_cndmask_b32 v35, v37, v36, vcc
    v_add_u32 v59, s75, v34
    v_add_u32 v60, s75, v35
    v_lshlrev_b32 v34, 2, v30
    v_lshl_add_u32 v34, v31, 9, v34
    v_add_u32 v61, s75, v34
    s_lshl_b32 s84, s66, 1
    s_add_u32 s84, s84, s88
    s_mul_i32 s84, s84, 172
    s_mul_i32 s85, s67, 6
    s_mul_i32 s78, s89, 3
    s_add_u32 s85, s85, s78
    s_add_u32 s84, s84, s85
    s_lshl_b32 s84, s84, 10
    s_add_u32 s84, s84, 7340032
    s_waitcnt vmcnt(6) lgkmcnt(0)
    s_lshl_b32 s74, s88, 4
    s_lshr_b32 s14, s14, s74
    v_mov_b32 v28, s14
    v_lshlrev_b32 v24, 16, v24
    v_lshlrev_b32 v25, 16, v25
    v_lshlrev_b32 v26, 16, v26
    v_lshlrev_b32 v27, 16, v27
    v_lshlrev_b32 v28, 16, v28
    v_mul_f32 v28, 0x3fb8aa3b, v28
    v_mul_f32 v24, 0x3fb8aa3b, v24
    v_exp_f32 v28, v28
    v_exp_f32 v24, v24
    s_nop 0
    v_cvt_pk_bf16_f32 v24, v24, v28
    v_and_b32 v28, 0xffff0000, v24
    v_lshlrev_b32 v24, 16, v24
    v_mul_f32 v24, v24, v28
    v_mul_f32 v25, v25, v28
    v_mul_f32 v24, 0xbfb8aa3b, v24
    v_mul_f32 v25, 0x3e22f983, v25
    v_add_f32 v28, v28, v28
    v_mul_f32 v64, v26, v28
    v_mul_f32 v65, v27, v28
    v_mul_f32 v116, 0x41000000, v24
    v_mul_f32 v117, 0x41000000, v25
    v_mul_f32 v120, 0x3f800000, v24
    v_mul_f32 v121, 0x3f800000, v25
    v_mul_f32 v124, 0x42000000, v24
    v_mul_f32 v125, 0x42000000, v25
    v_mul_f32 v128, 0x43800000, v24
    v_mul_f32 v129, 0x43800000, v25
    v_rndne_f32 v118, v117
    v_exp_f32 v116, v116
    v_rndne_f32 v122, v121
    v_exp_f32 v120, v120
    v_rndne_f32 v126, v125
    v_exp_f32 v124, v124
    v_rndne_f32 v130, v129
    v_exp_f32 v128, v128
    v_sub_f32 v117, v117, v118
    v_sub_f32 v121, v121, v122
    v_sub_f32 v125, v125, v126
    v_sub_f32 v129, v129, v130
    v_cos_f32 v32, v117
    v_sin_f32 v33, v117
    v_cos_f32 v30, v121
    v_sin_f32 v31, v121
    v_cos_f32 v36, v125
    v_sin_f32 v37, v125
    v_cos_f32 v34, v129
    v_sin_f32 v35, v129
    v_pk_mul_f32 v[32:33], v[32:33], v[116:117] op_sel_hi:[1,0]
    v_pk_mul_f32 v[30:31], v[30:31], v[120:121] op_sel_hi:[1,0]
    v_pk_mul_f32 v[36:37], v[36:37], v[124:125] op_sel_hi:[1,0]
    v_pk_mul_f32 v[34:35], v[34:35], v[128:129] op_sel_hi:[1,0]
    v_cvt_pk_bf16_f32 v136, v64, -v65
    v_pk_mul_f32 v[56:57], v[64:65], v[34:35] op_sel:[0,0] op_sel_hi:[0,1]
    v_mov_b32 v140, 0x00003f80
    v_cvt_pk_bf16_f32 v133, v32, v33
    v_pk_mul_f32 v[50:51], v[32:33], v[32:33] op_sel:[0,0] op_sel_hi:[0,1]
    v_pk_fma_f32 v[80:81], v[64:65], v[34:35], v[56:57] op_sel:[1,1,0] op_sel_hi:[1,0,1] neg_lo:[1,0,0]
    v_pk_fma_f32 v[42:43], v[32:33], v[32:33], v[50:51] op_sel:[1,1,0] op_sel_hi:[1,0,1] neg_lo:[1,0,0]
    v_cvt_pk_bf16_f32 v137, v80, -v81
    v_cvt_pk_bf16_f32 v132, v36, v37
    v_cvt_pk_bf16_f32 v134, v42, v43
    v_pk_mul_f32 v[54:55], v[64:65], v[30:31] op_sel:[0,0] op_sel_hi:[0,1]
    v_pk_mul_f32 v[56:57], v[80:81], v[34:35] op_sel:[0,0] op_sel_hi:[0,1]
    ds_write_addtid_b32 v136 offset:4096
    v_pk_mul_f32 v[46:47], v[36:37], v[36:37] op_sel:[0,0] op_sel_hi:[0,1]
    v_pk_mul_f32 v[48:49], v[32:33], v[36:37] op_sel:[0,0] op_sel_hi:[0,1]
    ds_write_addtid_b32 v140 offset:9808
    v_pk_mul_f32 v[52:53], v[42:43], v[32:33] op_sel:[0,0] op_sel_hi:[0,1]
    ds_write_addtid_b32 v133 offset:10080
    v_pk_fma_f32 v[66:67], v[64:65], v[30:31], v[54:55] op_sel:[1,1,0] op_sel_hi:[1,0,1] neg_lo:[1,0,0]
    v_pk_fma_f32 v[88:89], v[80:81], v[34:35], v[56:57] op_sel:[1,1,0] op_sel_hi:[1,0,1] neg_lo:[1,0,0]
    ds_write_addtid_b32 v137 offset:6272
    v_pk_fma_f32 v[38:39], v[36:37], v[36:37], v[46:47] op_sel:[1,1,0] op_sel_hi:[1,0,1] neg_lo:[1,0,0]
    v_pk_fma_f32 v[40:41], v[32:33], v[36:37], v[48:49] op_sel:[1,1,0] op_sel_hi:[1,0,1] neg_lo:[1,0,0]
    ds_write_addtid_b32 v132 offset:10896
    v_pk_fma_f32 v[44:45], v[42:43], v[32:33], v[52:53] op_sel:[1,1,0] op_sel_hi:[1,0,1] neg_lo:[1,0,0]
    ds_write_addtid_b32 v134 offset:10352
    v_cvt_pk_bf16_f32 v136, v66, -v67
    v_cvt_pk_bf16_f32 v137, v88, -v89
    v_cvt_pk_bf16_f32 v132, v38, v39
    v_cvt_pk_bf16_f32 v133, v40, v41
    v_cvt_pk_bf16_f32 v135, v44, v45
    v_pk_mul_f32 v[54:55], v[66:67], v[30:31] op_sel:[0,0] op_sel_hi:[0,1]
    v_pk_mul_f32 v[56:57], v[88:89], v[34:35] op_sel:[0,0] op_sel_hi:[0,1]
    v_pk_mul_f32 v[46:47], v[38:39], v[36:37] op_sel:[0,0] op_sel_hi:[0,1]
    ds_write_addtid_b32 v136 offset:4368
    v_pk_mul_f32 v[48:49], v[40:41], v[36:37] op_sel:[0,0] op_sel_hi:[0,1]
    v_pk_mul_f32 v[50:51], v[42:43], v[36:37] op_sel:[0,0] op_sel_hi:[0,1]
    ds_write_addtid_b32 v137 offset:7360
    v_pk_mul_f32 v[52:53], v[44:45], v[36:37] op_sel:[0,0] op_sel_hi:[0,1]
    v_pk_fma_f32 v[68:69], v[66:67], v[30:31], v[54:55] op_sel:[1,1,0] op_sel_hi:[1,0,1] neg_lo:[1,0,0]
    v_pk_fma_f32 v[92:93], v[88:89], v[34:35], v[56:57] op_sel:[1,1,0] op_sel_hi:[1,0,1] neg_lo:[1,0,0]
    ds_write_addtid_b32 v132 offset:11984
    v_pk_fma_f32 v[38:39], v[38:39], v[36:37], v[46:47] op_sel:[1,1,0] op_sel_hi:[1,0,1] neg_lo:[1,0,0]
    v_pk_fma_f32 v[40:41], v[40:41], v[36:37], v[48:49] op_sel:[1,1,0] op_sel_hi:[1,0,1] neg_lo:[1,0,0]
    ds_write_addtid_b32 v133 offset:11168
    v_pk_fma_f32 v[42:43], v[42:43], v[36:37], v[50:51] op_sel:[1,1,0] op_sel_hi:[1,0,1] neg_lo:[1,0,0]
    v_pk_fma_f32 v[44:45], v[44:45], v[36:37], v[52:53] op_sel:[1,1,0] op_sel_hi:[1,0,1] neg_lo:[1,0,0]
    ds_write_addtid_b32 v135 offset:10624
    v_cvt_pk_bf16_f32 v136, v68, -v69
    v_cvt_pk_bf16_f32 v137, v92, -v93
    v_cvt_pk_bf16_f32 v132, v38, v39
    v_cvt_pk_bf16_f32 v133, v40, v41
    v_cvt_pk_bf16_f32 v134, v42, v43
    v_cvt_pk_bf16_f32 v135, v44, v45
    v_pk_mul_f32 v[54:55], v[68:69], v[30:31] op_sel:[0,0] op_sel_hi:[0,1]
    v_pk_mul_f32 v[56:57], v[68:69], v[34:35] op_sel:[0,0] op_sel_hi:[0,1]
    ds_write_addtid_b32 v136 offset:4640
    v_pk_mul_f32 v[46:47], v[38:39], v[36:37] op_sel:[0,0] op_sel_hi:[0,1]
    v_pk_mul_f32 v[48:49], v[40:41], v[36:37] op_sel:[0,0] op_sel_hi:[0,1]
    ds_write_addtid_b32 v137 offset:7904
    v_pk_mul_f32 v[50:51], v[42:43], v[36:37] op_sel:[0,0] op_sel_hi:[0,1]
    v_pk_mul_f32 v[52:53], v[44:45], v[36:37] op_sel:[0,0] op_sel_hi:[0,1]
    ds_write_addtid_b32 v132 offset:13072
    v_pk_fma_f32 v[70:71], v[68:69], v[30:31], v[54:55] op_sel:[1,1,0] op_sel_hi:[1,0,1] neg_lo:[1,0,0]
    v_pk_fma_f32 v[82:83], v[68:69], v[34:35], v[56:57] op_sel:[1,1,0] op_sel_hi:[1,0,1] neg_lo:[1,0,0]
    ds_write_addtid_b32 v133 offset:12256
    v_pk_fma_f32 v[38:39], v[38:39], v[36:37], v[46:47] op_sel:[1,1,0] op_sel_hi:[1,0,1] neg_lo:[1,0,0]
    v_pk_fma_f32 v[40:41], v[40:41], v[36:37], v[48:49] op_sel:[1,1,0] op_sel_hi:[1,0,1] neg_lo:[1,0,0]
    ds_write_addtid_b32 v134 offset:11440
    v_pk_fma_f32 v[42:43], v[42:43], v[36:37], v[50:51] op_sel:[1,1,0] op_sel_hi:[1,0,1] neg_lo:[1,0,0]
    v_pk_fma_f32 v[44:45], v[44:45], v[36:37], v[52:53] op_sel:[1,1,0] op_sel_hi:[1,0,1] neg_lo:[1,0,0]
    ds_write_addtid_b32 v135 offset:11712
    v_cvt_pk_bf16_f32 v136, v70, -v71
    v_cvt_pk_bf16_f32 v137, v82, -v83
    v_cvt_pk_bf16_f32 v132, v38, v39
    v_cvt_pk_bf16_f32 v133, v40, v41
    v_cvt_pk_bf16_f32 v134, v42, v43
    v_cvt_pk_bf16_f32 v135, v44, v45
    v_pk_mul_f32 v[54:55], v[70:71], v[30:31] op_sel:[0,0] op_sel_hi:[0,1]
    v_pk_mul_f32 v[56:57], v[92:93], v[34:35] op_sel:[0,0] op_sel_hi:[0,1]
    ds_write_addtid_b32 v136 offset:4912
    v_pk_mul_f32 v[46:47], v[38:39], v[36:37] op_sel:[0,0] op_sel_hi:[0,1]
    v_pk_mul_f32 v[48:49], v[40:41], v[36:37] op_sel:[0,0] op_sel_hi:[0,1]
    ds_write_addtid_b32 v137 offset:6544
    v_pk_mul_f32 v[50:51], v[42:43], v[36:37] op_sel:[0,0] op_sel_hi:[0,1]
    v_pk_mul_f32 v[52:53], v[44:45], v[36:37] op_sel:[0,0] op_sel_hi:[0,1]
    ds_write_addtid_b32 v132 offset:14160
    v_pk_fma_f32 v[72:73], v[70:71], v[30:31], v[54:55] op_sel:[1,1,0] op_sel_hi:[1,0,1] neg_lo:[1,0,0]
    v_pk_fma_f32 v[96:97], v[92:93], v[34:35], v[56:57] op_sel:[1,1,0] op_sel_hi:[1,0,1] neg_lo:[1,0,0]
    ds_write_addtid_b32 v133 offset:13344
    v_pk_fma_f32 v[38:39], v[38:39], v[36:37], v[46:47] op_sel:[1,1,0] op_sel_hi:[1,0,1] neg_lo:[1,0,0]
    v_pk_fma_f32 v[40:41], v[40:41], v[36:37], v[48:49] op_sel:[1,1,0] op_sel_hi:[1,0,1] neg_lo:[1,0,0]
    ds_write_addtid_b32 v134 offset:12528
    v_pk_fma_f32 v[42:43], v[42:43], v[36:37], v[50:51] op_sel:[1,1,0] op_sel_hi:[1,0,1] neg_lo:[1,0,0]
    v_pk_fma_f32 v[44:45], v[44:45], v[36:37], v[52:53] op_sel:[1,1,0] op_sel_hi:[1,0,1] neg_lo:[1,0,0]
    ds_write_addtid_b32 v135 offset:12800
    v_cvt_pk_bf16_f32 v136, v72, -v73
    v_cvt_pk_bf16_f32 v137, v96, -v97
    v_cvt_pk_bf16_f32 v132, v38, v39
    v_cvt_pk_bf16_f32 v133, v40, v41
    v_cvt_pk_bf16_f32 v134, v42, v43
    v_cvt_pk_bf16_f32 v135, v44, v45
    v_pk_mul_f32 v[54:55], v[72:73], v[30:31] op_sel:[0,0] op_sel_hi:[0,1]
    v_pk_mul_f32 v[56:57], v[72:73], v[34:35] op_sel:[0,0] op_sel_hi:[0,1]
    ds_write_addtid_b32 v136 offset:5184
    v_pk_mul_f32 v[46:47], v[38:39], v[36:37] op_sel:[0,0] op_sel_hi:[0,1]
    v_pk_mul_f32 v[48:49], v[40:41], v[36:37] op_sel:[0,0] op_sel_hi:[0,1]
    ds_write_addtid_b32 v137 offset:8448
    v_pk_mul_f32 v[50:51], v[42:43], v[36:37] op_sel:[0,0] op_sel_hi:[0,1]
    v_pk_mul_f32 v[52:53], v[44:45], v[36:37] op_sel:[0,0] op_sel_hi:[0,1]
    ds_write_addtid_b32 v132 offset:15248
    v_pk_fma_f32 v[74:75], v[72:73], v[30:31], v[54:55] op_sel:[1,1,0] op_sel_hi:[1,0,1] neg_lo:[1,0,0]
    v_pk_fma_f32 v[84:85], v[72:73], v[34:35], v[56:57] op_sel:[1,1,0] op_sel_hi:[1,0,1] neg_lo:[1,0,0]
    ds_write_addtid_b32 v133 offset:14432
    v_pk_fma_f32 v[38:39], v[38:39], v[36:37], v[46:47] op_sel:[1,1,0] op_sel_hi:[1,0,1] neg_lo:[1,0,0]
    v_pk_fma_f32 v[40:41], v[40:41], v[36:37], v[48:49] op_sel:[1,1,0] op_sel_hi:[1,0,1] neg_lo:[1,0,0]
    ds_write_addtid_b32 v134 offset:13616
    v_pk_fma_f32 v[42:43], v[42:43], v[36:37], v[50:51] op_sel:[1,1,0] op_sel_hi:[1,0,1] neg_lo:[1,0,0]
    v_pk_fma_f32 v[44:45], v[44:45], v[36:37], v[52:53] op_sel:[1,1,0] op_sel_hi:[1,0,1] neg_lo:[1,0,0]
    ds_write_addtid_b32 v135 offset:13888
    v_cvt_pk_bf16_f32 v136, v74, -v75
    v_cvt_pk_bf16_f32 v137, v84, -v85
    v_cvt_pk_bf16_f32 v132, v38, v39
    v_cvt_pk_bf16_f32 v133, v40, v41
    v_cvt_pk_bf16_f32 v134, v42, v43
    v_cvt_pk_bf16_f32 v135, v44, v45
    v_pk_mul_f32 v[54:55], v[74:75], v[30:31] op_sel:[0,0] op_sel_hi:[0,1]
    v_pk_mul_f32 v[56:57], v[96:97], v[34:35] op_sel:[0,0] op_sel_hi:[0,1]
    ds_write_addtid_b32 v136 offset:5456
    v_pk_mul_f32 v[46:47], v[38:39], v[36:37] op_sel:[0,0] op_sel_hi:[0,1]
    v_pk_mul_f32 v[48:49], v[40:41], v[36:37] op_sel:[0,0] op_sel_hi:[0,1]
    ds_write_addtid_b32 v137 offset:6816
    v_pk_mul_f32 v[50:51], v[42:43], v[36:37] op_sel:[0,0] op_sel_hi:[0,1]
    v_pk_mul_f32 v[52:53], v[44:45], v[36:37] op_sel:[0,0] op_sel_hi:[0,1]
    ds_write_addtid_b32 v132 offset:16336
    v_pk_fma_f32 v[76:77], v[74:75], v[30:31], v[54:55] op_sel:[1,1,0] op_sel_hi:[1,0,1] neg_lo:[1,0,0]
    v_pk_fma_f32 v[98:99], v[96:97], v[34:35], v[56:57] op_sel:[1,1,0] op_sel_hi:[1,0,1] neg_lo:[1,0,0]
    ds_write_addtid_b32 v133 offset:15520
    v_pk_fma_f32 v[38:39], v[38:39], v[36:37], v[46:47] op_sel:[1,1,0] op_sel_hi:[1,0,1] neg_lo:[1,0,0]
    v_pk_fma_f32 v[40:41], v[40:41], v[36:37], v[48:49] op_sel:[1,1,0] op_sel_hi:[1,0,1] neg_lo:[1,0,0]
    ds_write_addtid_b32 v134 offset:14704
    v_pk_fma_f32 v[42:43], v[42:43], v[36:37], v[50:51] op_sel:[1,1,0] op_sel_hi:[1,0,1] neg_lo:[1,0,0]
    v_pk_fma_f32 v[44:45], v[44:45], v[36:37], v[52:53] op_sel:[1,1,0] op_sel_hi:[1,0,1] neg_lo:[1,0,0]
    ds_write_addtid_b32 v135 offset:14976
    v_cvt_pk_bf16_f32 v136, v76, -v77
    v_cvt_pk_bf16_f32 v137, v98, -v99
    v_cvt_pk_bf16_f32 v132, v38, v39
    v_cvt_pk_bf16_f32 v133, v40, v41
    v_cvt_pk_bf16_f32 v134, v42, v43
    v_cvt_pk_bf16_f32 v135, v44, v45
    v_pk_mul_f32 v[54:55], v[76:77], v[30:31] op_sel:[0,0] op_sel_hi:[0,1]
    v_pk_mul_f32 v[56:57], v[76:77], v[34:35] op_sel:[0,0] op_sel_hi:[0,1]
    ds_write_addtid_b32 v136 offset:5728
    v_pk_mul_f32 v[48:49], v[40:41], v[36:37] op_sel:[0,0] op_sel_hi:[0,1]
    v_pk_mul_f32 v[50:51], v[42:43], v[36:37] op_sel:[0,0] op_sel_hi:[0,1]
    ds_write_addtid_b32 v137 offset:8720
    v_pk_mul_f32 v[52:53], v[44:45], v[36:37] op_sel:[0,0] op_sel_hi:[0,1]
    ds_write_addtid_b32 v132 offset:17424
    v_pk_fma_f32 v[78:79], v[76:77], v[30:31], v[54:55] op_sel:[1,1,0] op_sel_hi:[1,0,1] neg_lo:[1,0,0]
    v_pk_fma_f32 v[86:87], v[76:77], v[34:35], v[56:57] op_sel:[1,1,0] op_sel_hi:[1,0,1] neg_lo:[1,0,0]
    ds_write_addtid_b32 v133 offset:16608
    v_pk_fma_f32 v[40:41], v[40:41], v[36:37], v[48:49] op_sel:[1,1,0] op_sel_hi:[1,0,1] neg_lo:[1,0,0]
    v_pk_fma_f32 v[42:43], v[42:43], v[36:37], v[50:51] op_sel:[1,1,0] op_sel_hi:[1,0,1] neg_lo:[1,0,0]
    ds_write_addtid_b32 v134 offset:15792
    v_pk_fma_f32 v[44:45], v[44:45], v[36:37], v[52:53] op_sel:[1,1,0] op_sel_hi:[1,0,1] neg_lo:[1,0,0]
    ds_write_addtid_b32 v135 offset:16064
    v_cvt_pk_bf16_f32 v136, v78, -v79
    v_cvt_pk_bf16_f32 v137, v86, -v87
    v_cvt_pk_bf16_f32 v133, v40, v41
    v_cvt_pk_bf16_f32 v134, v42, v43
    v_cvt_pk_bf16_f32 v135, v44, v45
    v_pk_mul_f32 v[54:55], v[84:85], v[34:35] op_sel:[0,0] op_sel_hi:[0,1]
    v_pk_mul_f32 v[56:57], v[98:99], v[34:35] op_sel:[0,0] op_sel_hi:[0,1]
    ds_write_addtid_b32 v136 offset:6000
    v_pk_mul_f32 v[50:51], v[42:43], v[36:37] op_sel:[0,0] op_sel_hi:[0,1]
    v_pk_mul_f32 v[52:53], v[44:45], v[36:37] op_sel:[0,0] op_sel_hi:[0,1]
    ds_write_addtid_b32 v137 offset:7088
    v_pk_fma_f32 v[90:91], v[84:85], v[34:35], v[54:55] op_sel:[1,1,0] op_sel_hi:[1,0,1] neg_lo:[1,0,0]
    ds_write_addtid_b32 v133 offset:17696
    v_pk_fma_f32 v[100:101], v[98:99], v[34:35], v[56:57] op_sel:[1,1,0] op_sel_hi:[1,0,1] neg_lo:[1,0,0]
    v_pk_fma_f32 v[42:43], v[42:43], v[36:37], v[50:51] op_sel:[1,1,0] op_sel_hi:[1,0,1] neg_lo:[1,0,0]
    ds_write_addtid_b32 v134 offset:16880
    v_pk_fma_f32 v[44:45], v[44:45], v[36:37], v[52:53] op_sel:[1,1,0] op_sel_hi:[1,0,1] neg_lo:[1,0,0]
    ds_write_addtid_b32 v135 offset:17152
    v_cvt_pk_bf16_f32 v136, v90, -v91
    v_cvt_pk_bf16_f32 v137, v100, -v101
    v_cvt_pk_bf16_f32 v134, v42, v43
    v_cvt_pk_bf16_f32 v135, v44, v45
    v_pk_mul_f32 v[54:55], v[90:91], v[34:35] op_sel:[0,0] op_sel_hi:[0,1]
    ds_write_addtid_b32 v136 offset:7632
    v_pk_mul_f32 v[56:57], v[100:101], v[34:35] op_sel:[0,0] op_sel_hi:[0,1]
    ds_write_addtid_b32 v137 offset:8992
    v_pk_fma_f32 v[94:95], v[90:91], v[34:35], v[54:55] op_sel:[1,1,0] op_sel_hi:[1,0,1] neg_lo:[1,0,0]
    ds_write_addtid_b32 v134 offset:17968
    v_pk_fma_f32 v[102:103], v[100:101], v[34:35], v[56:57] op_sel:[1,1,0] op_sel_hi:[1,0,1] neg_lo:[1,0,0]
    ds_write_addtid_b32 v135 offset:18240
    v_cvt_pk_bf16_f32 v136, v94, -v95
    v_cvt_pk_bf16_f32 v137, v102, -v103
    v_pk_mul_f32 v[56:57], v[102:103], v[34:35] op_sel:[0,0] op_sel_hi:[0,1]
    ds_write_addtid_b32 v136 offset:8176
    v_pk_fma_f32 v[104:105], v[102:103], v[34:35], v[56:57] op_sel:[1,1,0] op_sel_hi:[1,0,1] neg_lo:[1,0,0]
    ds_write_addtid_b32 v137 offset:9264
    v_cvt_pk_bf16_f32 v137, v104, -v105
    ds_write_addtid_b32 v137 offset:9536
    s_waitcnt lgkmcnt(0)
    ds_read_b128 v[64:67], v14 offset:0
    ds_read_b128 v[68:71], v14 offset:5712
    ds_read_b128 v[72:75], v14 offset:32
    ds_read_b128 v[76:79], v14 offset:5744
    ds_read_b128 v[80:83], v14 offset:64
    ds_read_b128 v[84:87], v14 offset:5776
    ds_read_b128 v[88:91], v14 offset:96
    ds_read_b128 v[92:95], v14 offset:5808
    ds_read_b128 v[96:99], v14 offset:128
    ds_read_b128 v[100:103], v14 offset:5840
    ds_read_b128 v[104:107], v14 offset:160
    ds_read_b128 v[108:111], v14 offset:5872
    ds_read_b128 v[112:115], v14 offset:192
    ds_read_b128 v[116:119], v14 offset:5904
    ds_read_b128 v[120:123], v14 offset:224
    ds_read_b128 v[124:127], v14 offset:5936
    s_mul_i32 s74, s89, 1536
    v_lshl_add_u32 v48, v1, 3, s74
    s_lshl_b32 s74, s88, 10
    v_and_b32 v49, 0x1ff, v12
    v_add_u32 v49, s74, v49
    s_waitcnt lgkmcnt(14)
    v_mfma_f32_32x32x16_bf16 v[32:47], v[64:67], v[68:71], 0
    s_waitcnt lgkmcnt(12)
    v_mfma_f32_32x32x16_bf16 v[32:47], v[72:75], v[76:79], v[32:47]
    s_waitcnt lgkmcnt(10)
    v_mfma_f32_32x32x16_bf16 v[32:47], v[80:83], v[84:87], v[32:47]
    s_waitcnt lgkmcnt(8)
    v_mfma_f32_32x32x16_bf16 v[32:47], v[88:91], v[92:95], v[32:47]
    s_waitcnt lgkmcnt(6)
    v_mfma_f32_32x32x16_bf16 v[32:47], v[96:99], v[100:103], v[32:47]
    s_waitcnt lgkmcnt(4)
    v_mfma_f32_32x32x16_bf16 v[32:47], v[104:107], v[108:111], v[32:47]
    s_waitcnt lgkmcnt(2)
    v_mfma_f32_32x32x16_bf16 v[32:47], v[112:115], v[116:119], v[32:47]
    s_waitcnt lgkmcnt(0)
    v_mfma_f32_32x32x16_bf16 v[32:47], v[120:123], v[124:127], v[32:47]
    s_nop 11
    ds_write_b128 v58, v[32:35]
    ds_write_b64 v59, v[36:37]
    ds_write_b64 v60, v[38:39]
    ds_write_b32 v61, v40 offset:2048
    ds_write_b32 v61, v41 offset:2176
    ds_write_b32 v61, v42 offset:2304
    ds_write_b32 v61, v43 offset:2432
    s_waitcnt vmcnt(0)
    v_readfirstlane_b32 s69, v29
    s_nop 0
    s_mul_i32 s69, s69, 0x9E3779B1
    s_add_u32 s69, s69, 0x7F4A7C15
    s_cmp_ge_u32 s85, 86
    s_cbranch_scc1 L_idle
    s_barrier
    ds_read_b128 v[208:211], v2 offset:41024
    ds_read_b64_tr_b16 v[216:217], v10 offset:41024
    ds_read_b64_tr_b16 v[218:219], v10 offset:41792
    ds_read_b128 v[212:215], v2 offset:45120
    ds_read_b64_tr_b16 v[220:221], v10 offset:41056
    ds_read_b64_tr_b16 v[222:223], v10 offset:41824
    ds_read_b64_tr_b16 v[224:225], v10 offset:41088
    ds_read_b64_tr_b16 v[226:227], v10 offset:41856
    s_waitcnt lgkmcnt(0)
    v_mfma_f32_32x32x16_bf16 v[64:79], v[216:219], v[208:211], 0
    ds_read_b128 v[228:231], v3 offset:41024
    ds_read_b64_tr_b16 v[236:237], v10 offset:44096
    ds_read_b64_tr_b16 v[238:239], v10 offset:44864
    v_mfma_f32_32x32x16_bf16 v[80:95], v[216:219], v[212:215], 0
    ds_read_b128 v[232:235], v3 offset:45120
    ds_read_b64_tr_b16 v[240:241], v10 offset:44128
    ds_read_b64_tr_b16 v[242:243], v10 offset:44896
    v_mfma_f32_32x32x16_bf16 v[96:111], v[220:223], v[208:211], 0
    ds_read_b64_tr_b16 v[244:245], v10 offset:44160
    ds_read_b64_tr_b16 v[246:247], v10 offset:44928
    v_mfma_f32_32x32x16_bf16 v[112:127], v[220:223], v[212:215], 0
    v_mfma_f32_32x32x16_bf16 v[128:143], v[224:227], v[208:211], 0
    v_mfma_f32_32x32x16_bf16 v[144:159], v[224:227], v[212:215], 0
    s_waitcnt lgkmcnt(0)
    v_mfma_f32_32x32x16_bf16 v[64:79], v[236:239], v[228:231], v[64:79]
    ds_read_b128 v[208:211], v4 offset:41024
    ds_read_b64_tr_b16 v[216:217], v10 offset:47168
    ds_read_b64_tr_b16 v[218:219], v10 offset:47936
    v_mfma_f32_32x32x16_bf16 v[80:95], v[236:239], v[232:235], v[80:95]
    ds_read_b128 v[212:215], v4 offset:45120
    ds_read_b64_tr_b16 v[220:221], v10 offset:47200
    ds_read_b64_tr_b16 v[222:223], v10 offset:47968
    v_mfma_f32_32x32x16_bf16 v[96:111], v[240:243], v[228:231], v[96:111]
    ds_read_b64_tr_b16 v[224:225], v10 offset:47232
    ds_read_b64_tr_b16 v[226:227], v10 offset:48000
    v_mfma_f32_32x32x16_bf16 v[112:127], v[240:243], v[232:235], v[112:127]
    v_mfma_f32_32x32x16_bf16 v[128:143], v[244:247], v[228:231], v[128:143]
    v_mfma_f32_32x32x16_bf16 v[144:159], v[244:247], v[232:235], v[144:159]
    s_waitcnt lgkmcnt(0)
    v_mfma_f32_32x32x16_bf16 v[64:79], v[216:219], v[208:211], v[64:79]
    ds_read_b128 v[228:231], v5 offset:41024
    ds_read_b64_tr_b16 v[236:237], v10 offset:50240
    ds_read_b64_tr_b16 v[238:239], v10 offset:51008
    v_mfma_f32_32x32x16_bf16 v[80:95], v[216:219], v[212:215], v[80:95]
    ds_read_b128 v[232:235], v5 offset:45120
    ds_read_b64_tr_b16 v[240:241], v10 offset:50272
    ds_read_b64_tr_b16 v[242:243], v10 offset:51040
    v_mfma_f32_32x32x16_bf16 v[96:111], v[220:223], v[208:211], v[96:111]
    ds_read_b64_tr_b16 v[244:245], v10 offset:50304
    ds_read_b64_tr_b16 v[246:247], v10 offset:51072
    v_mfma_f32_32x32x16_bf16 v[112:127], v[220:223], v[212:215], v[112:127]
    v_mfma_f32_32x32x16_bf16 v[128:143], v[224:227], v[208:211], v[128:143]
    v_mfma_f32_32x32x16_bf16 v[144:159], v[224:227], v[212:215], v[144:159]
    s_waitcnt lgkmcnt(0)
    s_barrier
    v_mfma_f32_32x32x16_bf16 v[64:79], v[236:239], v[228:231], v[64:79]
    ds_read_b128 v[208:211], v6 offset:0
    ds_read_b64_tr_b16 v[216:217], v11 offset:0
    ds_read_b64_tr_b16 v[218:219], v11 offset:768
    v_mfma_f32_32x32x16_bf16 v[80:95], v[236:239], v[232:235], v[80:95]
    ds_read_b128 v[212:215], v6 offset:4096
    ds_read_b64_tr_b16 v[220:221], v11 offset:32
    ds_read_b64_tr_b16 v[222:223], v11 offset:800
    v_mfma_f32_32x32x16_bf16 v[96:111], v[240:243], v[228:231], v[96:111]
    ds_read_b64_tr_b16 v[224:225], v11 offset:64
    ds_read_b64_tr_b16 v[226:227], v11 offset:832
    v_mfma_f32_32x32x16_bf16 v[112:127], v[240:243], v[232:235], v[112:127]
    v_mfma_f32_32x32x16_bf16 v[128:143], v[244:247], v[228:231], v[128:143]
    v_mfma_f32_32x32x16_bf16 v[144:159], v[244:247], v[232:235], v[144:159]
    s_waitcnt lgkmcnt(0)
    v_mfma_f32_32x32x16_bf16 v[64:79], v[216:219], v[208:211], v[64:79]
    ds_read_b128 v[228:231], v7 offset:0
    ds_read_b64_tr_b16 v[236:237], v11 offset:3072
    ds_read_b64_tr_b16 v[238:239], v11 offset:3840
    v_mfma_f32_32x32x16_bf16 v[80:95], v[216:219], v[212:215], v[80:95]
    ds_read_b128 v[232:235], v7 offset:4096
    ds_read_b64_tr_b16 v[240:241], v11 offset:3104
    ds_read_b64_tr_b16 v[242:243], v11 offset:3872
    v_mfma_f32_32x32x16_bf16 v[96:111], v[220:223], v[208:211], v[96:111]
    ds_read_b64_tr_b16 v[244:245], v11 offset:3136
    ds_read_b64_tr_b16 v[246:247], v11 offset:3904
    v_mfma_f32_32x32x16_bf16 v[112:127], v[220:223], v[212:215], v[112:127]
    v_mfma_f32_32x32x16_bf16 v[128:143], v[224:227], v[208:211], v[128:143]
    v_mfma_f32_32x32x16_bf16 v[144:159], v[224:227], v[212:215], v[144:159]
    s_waitcnt lgkmcnt(0)
    v_mfma_f32_32x32x16_bf16 v[64:79], v[236:239], v[228:231], v[64:79]
    ds_read_b128 v[208:211], v8 offset:0
    ds_read_b64_tr_b16 v[216:217], v11 offset:6144
    ds_read_b64_tr_b16 v[218:219], v11 offset:6912
    v_mfma_f32_32x32x16_bf16 v[80:95], v[236:239], v[232:235], v[80:95]
    ds_read_b128 v[212:215], v8 offset:4096
    ds_read_b64_tr_b16 v[220:221], v11 offset:6176
    ds_read_b64_tr_b16 v[222:223], v11 offset:6944
    v_mfma_f32_32x32x16_bf16 v[96:111], v[240:243], v[228:231], v[96:111]
    ds_read_b64_tr_b16 v[224:225], v11 offset:6208
    ds_read_b64_tr_b16 v[226:227], v11 offset:6976
    v_mfma_f32_32x32x16_bf16 v[112:127], v[240:243], v[232:235], v[112:127]
    v_mfma_f32_32x32x16_bf16 v[128:143], v[244:247], v[228:231], v[128:143]
    v_mfma_f32_32x32x16_bf16 v[144:159], v[244:247], v[232:235], v[144:159]
    s_waitcnt lgkmcnt(0)
    v_mfma_f32_32x32x16_bf16 v[64:79], v[216:219], v[208:211], v[64:79]
    ds_read_b128 v[228:231], v9 offset:0
    ds_read_b64_tr_b16 v[236:237], v11 offset:9216
    ds_read_b64_tr_b16 v[238:239], v11 offset:9984
    v_mfma_f32_32x32x16_bf16 v[80:95], v[216:219], v[212:215], v[80:95]
    ds_read_b128 v[232:235], v9 offset:4096
    ds_read_b64_tr_b16 v[240:241], v11 offset:9248
    ds_read_b64_tr_b16 v[242:243], v11 offset:10016
    v_mfma_f32_32x32x16_bf16 v[96:111], v[220:223], v[208:211], v[96:111]
    ds_read_b64_tr_b16 v[244:245], v11 offset:9280
    ds_read_b64_tr_b16 v[246:247], v11 offset:10048
    v_mfma_f32_32x32x16_bf16 v[112:127], v[220:223], v[212:215], v[112:127]
    v_mfma_f32_32x32x16_bf16 v[128:143], v[224:227], v[208:211], v[128:143]
    v_mfma_f32_32x32x16_bf16 v[144:159], v[224:227], v[212:215], v[144:159]
    s_waitcnt lgkmcnt(0)
    s_barrier
    v_mfma_f32_32x32x16_bf16 v[64:79], v[236:239], v[228:231], v[64:79]
    ds_read_b128 v[208:211], v2 offset:0
    ds_read_b64_tr_b16 v[216:217], v10 offset:0
    ds_read_b64_tr_b16 v[218:219], v10 offset:768
    v_mfma_f32_32x32x16_bf16 v[80:95], v[236:239], v[232:235], v[80:95]
    ds_read_b128 v[212:215], v2 offset:4096
    ds_read_b64_tr_b16 v[220:221], v10 offset:32
    ds_read_b64_tr_b16 v[222:223], v10 offset:800
    v_mfma_f32_32x32x16_bf16 v[96:111], v[240:243], v[228:231], v[96:111]
    ds_read_b64_tr_b16 v[224:225], v10 offset:64
    ds_read_b64_tr_b16 v[226:227], v10 offset:832
    v_mfma_f32_32x32x16_bf16 v[112:127], v[240:243], v[232:235], v[112:127]
    v_mfma_f32_32x32x16_bf16 v[128:143], v[244:247], v[228:231], v[128:143]
    v_mfma_f32_32x32x16_bf16 v[144:159], v[244:247], v[232:235], v[144:159]
    s_waitcnt lgkmcnt(0)
    v_mfma_f32_32x32x16_bf16 v[64:79], v[216:219], v[208:211], v[64:79]
    ds_read_b128 v[228:231], v3 offset:0
    ds_read_b64_tr_b16 v[236:237], v10 offset:3072
    ds_read_b64_tr_b16 v[238:239], v10 offset:3840
    v_mfma_f32_32x32x16_bf16 v[80:95], v[216:219], v[212:215], v[80:95]
    ds_read_b128 v[232:235], v3 offset:4096
    ds_read_b64_tr_b16 v[240:241], v10 offset:3104
    ds_read_b64_tr_b16 v[242:243], v10 offset:3872
    v_mfma_f32_32x32x16_bf16 v[96:111], v[220:223], v[208:211], v[96:111]
    ds_read_b64_tr_b16 v[244:245], v10 offset:3136
    ds_read_b64_tr_b16 v[246:247], v10 offset:3904
    v_mfma_f32_32x32x16_bf16 v[112:127], v[220:223], v[212:215], v[112:127]
    v_mfma_f32_32x32x16_bf16 v[128:143], v[224:227], v[208:211], v[128:143]
    v_mfma_f32_32x32x16_bf16 v[144:159], v[224:227], v[212:215], v[144:159]
    s_waitcnt lgkmcnt(0)
    v_mfma_f32_32x32x16_bf16 v[64:79], v[236:239], v[228:231], v[64:79]
    ds_read_b128 v[208:211], v4 offset:0
    ds_read_b64_tr_b16 v[216:217], v10 offset:6144
    ds_read_b64_tr_b16 v[218:219], v10 offset:6912
    v_mfma_f32_32x32x16_bf16 v[80:95], v[236:239], v[232:235], v[80:95]
    ds_read_b128 v[212:215], v4 offset:4096
    ds_read_b64_tr_b16 v[220:221], v10 offset:6176
    ds_read_b64_tr_b16 v[222:223], v10 offset:6944
    v_mfma_f32_32x32x16_bf16 v[96:111], v[240:243], v[228:231], v[96:111]
    ds_read_b64_tr_b16 v[224:225], v10 offset:6208
    ds_read_b64_tr_b16 v[226:227], v10 offset:6976
    v_mfma_f32_32x32x16_bf16 v[112:127], v[240:243], v[232:235], v[112:127]
    v_mfma_f32_32x32x16_bf16 v[128:143], v[244:247], v[228:231], v[128:143]
    v_mfma_f32_32x32x16_bf16 v[144:159], v[244:247], v[232:235], v[144:159]
    s_waitcnt lgkmcnt(0)
    v_mfma_f32_32x32x16_bf16 v[64:79], v[216:219], v[208:211], v[64:79]
    ds_read_b128 v[228:231], v5 offset:0
    ds_read_b64_tr_b16 v[236:237], v10 offset:9216
    ds_read_b64_tr_b16 v[238:239], v10 offset:9984
    v_mfma_f32_32x32x16_bf16 v[80:95], v[216:219], v[212:215], v[80:95]
    ds_read_b128 v[232:235], v5 offset:4096
    ds_read_b64_tr_b16 v[240:241], v10 offset:9248
    ds_read_b64_tr_b16 v[242:243], v10 offset:10016
    v_mfma_f32_32x32x16_bf16 v[96:111], v[220:223], v[208:211], v[96:111]
    ds_read_b64_tr_b16 v[244:245], v10 offset:9280
    ds_read_b64_tr_b16 v[246:247], v10 offset:10048
    v_mfma_f32_32x32x16_bf16 v[112:127], v[220:223], v[212:215], v[112:127]
    v_mfma_f32_32x32x16_bf16 v[128:143], v[224:227], v[208:211], v[128:143]
    v_mfma_f32_32x32x16_bf16 v[144:159], v[224:227], v[212:215], v[144:159]
    s_waitcnt lgkmcnt(0)
    s_barrier
    v_mfma_f32_32x32x16_bf16 v[64:79], v[236:239], v[228:231], v[64:79]
    ds_read_b128 v[208:211], v2 offset:41024
    ds_read_b64_tr_b16 v[216:217], v10 offset:41024
    ds_read_b64_tr_b16 v[218:219], v10 offset:41792
    v_mfma_f32_32x32x16_bf16 v[80:95], v[236:239], v[232:235], v[80:95]
    ds_read_b128 v[212:215], v2 offset:45120
    ds_read_b64_tr_b16 v[220:221], v10 offset:41056
    ds_read_b64_tr_b16 v[222:223], v10 offset:41824
    v_mfma_f32_32x32x16_bf16 v[96:111], v[240:243], v[228:231], v[96:111]
    ds_read_b64_tr_b16 v[224:225], v10 offset:41088
    ds_read_b64_tr_b16 v[226:227], v10 offset:41856
    v_mfma_f32_32x32x16_bf16 v[112:127], v[240:243], v[232:235], v[112:127]
    v_lshrrev_b32 v14, 3, v1
    v_bfe_u32 v15, v1, 4, 1
    v_mfma_f32_32x32x16_bf16 v[128:143], v[244:247], v[228:231], v[128:143]
    v_lshlrev_b32 v15, 2, v15
    v_and_b32 v13, 7, v1
    v_mfma_f32_32x32x16_bf16 v[144:159], v[244:247], v[232:235], v[144:159]
    v_xor_b32 v13, v13, v15
    v_lshlrev_b32 v13, 4, v13
    v_lshl_add_u32 v13, v14, 10, v13
    s_waitcnt lgkmcnt(0)
    v_mfma_f32_32x32x16_bf16 v[64:79], v[216:219], v[208:211], v[64:79]
    ds_read_b128 v[228:231], v3 offset:41024
    ds_read_b64_tr_b16 v[236:237], v10 offset:44096
    ds_read_b64_tr_b16 v[238:239], v10 offset:44864
    v_mfma_f32_32x32x16_bf16 v[80:95], v[216:219], v[212:215], v[80:95]
    ds_read_b128 v[232:235], v3 offset:45120
    ds_read_b64_tr_b16 v[240:241], v10 offset:44128
    ds_read_b64_tr_b16 v[242:243], v10 offset:44896
    v_mfma_f32_32x32x16_bf16 v[96:111], v[220:223], v[208:211], v[96:111]
    ds_read_b64_tr_b16 v[244:245], v10 offset:44160
    ds_read_b64_tr_b16 v[246:247], v10 offset:44928
    v_mfma_f32_32x32x16_bf16 v[112:127], v[220:223], v[212:215], v[112:127]
    v_bfe_u32 v14, v1, 2, 2
    v_lshrrev_b32 v15, 5, v1
    v_mfma_f32_32x32x16_bf16 v[128:143], v[224:227], v[208:211], v[128:143]
    v_lshl_add_u32 v15, v15, 2, v14
    v_lshrrev_b32 v14, 1, v14
    v_mfma_f32_32x32x16_bf16 v[144:159], v[224:227], v[212:215], v[144:159]
    v_lshlrev_b32 v14, 2, v14
    v_bfe_u32 v62, v1, 4, 1
    v_lshlrev_b32 v62, 1, v62
    s_waitcnt lgkmcnt(0)
    v_mfma_f32_32x32x16_bf16 v[64:79], v[236:239], v[228:231], v[64:79]
    ds_read_b128 v[208:211], v4 offset:41024
    ds_read_b64_tr_b16 v[216:217], v10 offset:47168
    ds_read_b64_tr_b16 v[218:219], v10 offset:47936
    v_mfma_f32_32x32x16_bf16 v[80:95], v[236:239], v[232:235], v[80:95]
    ds_read_b128 v[212:215], v4 offset:45120
    ds_read_b64_tr_b16 v[220:221], v10 offset:47200
    ds_read_b64_tr_b16 v[222:223], v10 offset:47968
    v_mfma_f32_32x32x16_bf16 v[96:111], v[240:243], v[228:231], v[96:111]
    ds_read_b64_tr_b16 v[224:225], v10 offset:47232
    ds_read_b64_tr_b16 v[226:227], v10 offset:48000
    v_mfma_f32_32x32x16_bf16 v[112:127], v[240:243], v[232:235], v[112:127]
    v_bfe_u32 v63, v1, 1, 1
    v_add_u32 v62, v62, v63
    v_mfma_f32_32x32x16_bf16 v[128:143], v[244:247], v[228:231], v[128:143]
    v_xor_b32 v62, v62, v14
    v_lshlrev_b32 v62, 4, v62
    v_mfma_f32_32x32x16_bf16 v[144:159], v[244:247], v[232:235], v[144:159]
    v_lshl_add_u32 v62, v15, 7, v62
    v_and_b32 v63, 1, v1
    v_lshl_add_u32 v62, v63, 3, v62
    s_waitcnt lgkmcnt(0)
    v_mfma_f32_32x32x16_bf16 v[64:79], v[216:219], v[208:211], v[64:79]
    ds_read_b128 v[228:231], v5 offset:41024
    ds_read_b64_tr_b16 v[236:237], v10 offset:50240
    ds_read_b64_tr_b16 v[238:239], v10 offset:51008
    v_mfma_f32_32x32x16_bf16 v[80:95], v[216:219], v[212:215], v[80:95]
    ds_read_b128 v[232:235], v5 offset:45120
    ds_read_b64_tr_b16 v[240:241], v10 offset:50272
    ds_read_b64_tr_b16 v[242:243], v10 offset:51040
    v_mfma_f32_32x32x16_bf16 v[96:111], v[220:223], v[208:211], v[96:111]
    ds_read_b64_tr_b16 v[244:245], v10 offset:50304
    ds_read_b64_tr_b16 v[246:247], v10 offset:51072
    v_mfma_f32_32x32x16_bf16 v[112:127], v[220:223], v[212:215], v[112:127]
    s_lshl_b32 s74, s89, 11
    v_add_u32 v50, s74, v62
    v_mfma_f32_32x32x16_bf16 v[128:143], v[224:227], v[208:211], v[128:143]
    v_xor_b32 v51, 64, v50
    v_add_u32 v52, 65536, v50
    v_mfma_f32_32x32x16_bf16 v[144:159], v[224:227], v[212:215], v[144:159]
    v_add_u32 v53, 65536, v51
    v_add_u32 v54, 131072, v50
    v_add_u32 v55, 131072, v51
    s_waitcnt lgkmcnt(0)
    s_barrier
    v_mfma_f32_32x32x16_bf16 v[64:79], v[236:239], v[228:231], v[64:79]
    ds_read_b128 v[208:211], v6 offset:0
    ds_read_b64_tr_b16 v[216:217], v11 offset:0
    ds_read_b64_tr_b16 v[218:219], v11 offset:768
    v_mfma_f32_32x32x16_bf16 v[80:95], v[236:239], v[232:235], v[80:95]
    ds_read_b128 v[212:215], v6 offset:4096
    ds_read_b64_tr_b16 v[220:221], v11 offset:32
    ds_read_b64_tr_b16 v[222:223], v11 offset:800
    v_mfma_f32_32x32x16_bf16 v[96:111], v[240:243], v[228:231], v[96:111]
    ds_read_b64_tr_b16 v[224:225], v11 offset:64
    ds_read_b64_tr_b16 v[226:227], v11 offset:832
    v_mfma_f32_32x32x16_bf16 v[112:127], v[240:243], v[232:235], v[112:127]
    s_lshl_b32 s76, s70, 10
    s_lshl_b32 s77, s76, 3
    v_mfma_f32_32x32x16_bf16 v[128:143], v[244:247], v[228:231], v[128:143]
    s_lshl_b32 s78, s92, 7
    s_add_u32 s77, s77, s78
    v_mfma_f32_32x32x16_bf16 v[144:159], v[244:247], v[232:235], v[144:159]
    s_lshl1_add_u32 s74, s91, s88
    s_mul_i32 s74, s74, 86
    s_add_u32 s74, s74, s89
    s_waitcnt lgkmcnt(0)
    v_mfma_f32_32x32x16_bf16 v[64:79], v[216:219], v[208:211], v[64:79]
    ds_read_b128 v[228:231], v7 offset:0
    ds_read_b64_tr_b16 v[236:237], v11 offset:3072
    ds_read_b64_tr_b16 v[238:239], v11 offset:3840
    v_mfma_f32_32x32x16_bf16 v[80:95], v[216:219], v[212:215], v[80:95]
    ds_read_b128 v[232:235], v7 offset:4096
    ds_read_b64_tr_b16 v[240:241], v11 offset:3104
    ds_read_b64_tr_b16 v[242:243], v11 offset:3872
    v_mfma_f32_32x32x16_bf16 v[96:111], v[220:223], v[208:211], v[96:111]
    ds_read_b64_tr_b16 v[244:245], v11 offset:3136
    ds_read_b64_tr_b16 v[246:247], v11 offset:3904
    v_mfma_f32_32x32x16_bf16 v[112:127], v[220:223], v[212:215], v[112:127]
    s_lshl_b32 s83, s74, 10
    s_add_u32 s79, s83, 7340032
    v_mfma_f32_32x32x16_bf16 v[128:143], v[224:227], v[208:211], v[128:143]
    v_and_b32 v46, 31, v1
    v_mul_u32_u24 v46, 272, v46
    v_mfma_f32_32x32x16_bf16 v[144:159], v[224:227], v[212:215], v[144:159]
    v_lshrrev_b32 v47, 5, v1
    v_lshl_add_u32 v46, v47, 4, v46
    s_mul_i32 s74, s89, 17408
    s_waitcnt lgkmcnt(0)
    v_mfma_f32_32x32x16_bf16 v[64:79], v[236:239], v[228:231], v[64:79]
    ds_read_b128 v[208:211], v8 offset:0
    ds_read_b64_tr_b16 v[216:217], v11 offset:6144
    ds_read_b64_tr_b16 v[218:219], v11 offset:6912
    v_mfma_f32_32x32x16_bf16 v[80:95], v[236:239], v[232:235], v[80:95]
    ds_read_b128 v[212:215], v8 offset:4096
    ds_read_b64_tr_b16 v[220:221], v11 offset:6176
    ds_read_b64_tr_b16 v[222:223], v11 offset:6944
    v_mfma_f32_32x32x16_bf16 v[96:111], v[240:243], v[228:231], v[96:111]
    ds_read_b64_tr_b16 v[224:225], v11 offset:6208
    ds_read_b64_tr_b16 v[226:227], v11 offset:6976
    v_mfma_f32_32x32x16_bf16 v[112:127], v[240:243], v[232:235], v[112:127]
    s_mul_i32 s75, s88, 8704
    s_add_u32 s74, s74, s75
    v_mfma_f32_32x32x16_bf16 v[128:143], v[244:247], v[228:231], v[128:143]
    s_add_u32 s74, s74, 89920
    v_add_u32 v46, s74, v46
    v_mfma_f32_32x32x16_bf16 v[144:159], v[244:247], v[232:235], v[144:159]
    s_lshl1_add_u32 s81, s66, s88
    s_lshl4_add_u32 s81, s81, s67
    s_lshl1_add_u32 s81, s81, s89
    s_waitcnt lgkmcnt(0)
    v_mfma_f32_32x32x16_bf16 v[64:79], v[216:219], v[208:211], v[64:79]
    ds_read_b128 v[228:231], v9 offset:0
    ds_read_b64_tr_b16 v[236:237], v11 offset:9216
    ds_read_b64_tr_b16 v[238:239], v11 offset:9984
    v_mfma_f32_32x32x16_bf16 v[80:95], v[216:219], v[212:215], v[80:95]
    ds_read_b128 v[232:235], v9 offset:4096
    ds_read_b64_tr_b16 v[240:241], v11 offset:9248
    ds_read_b64_tr_b16 v[242:243], v11 offset:10016
    v_mfma_f32_32x32x16_bf16 v[96:111], v[220:223], v[208:211], v[96:111]
    ds_read_b64_tr_b16 v[244:245], v11 offset:9280
    ds_read_b64_tr_b16 v[246:247], v11 offset:10048
    v_mfma_f32_32x32x16_bf16 v[112:127], v[220:223], v[212:215], v[112:127]
    s_lshl_b32 s81, s81, 7
    s_add_u32 s81, s81, 327680
    v_mfma_f32_32x32x16_bf16 v[128:143], v[224:227], v[208:211], v[128:143]
    v_mov_b32 v45, s69
    v_min_u32 v47, 28, v1
    v_mfma_f32_32x32x16_bf16 v[144:159], v[224:227], v[212:215], v[144:159]
    v_lshlrev_b32 v47, 7, v47
    s_lshl_b32 s82, s91, 12
    s_add_u32 s82, s82, 327680
    s_waitcnt lgkmcnt(0)
    s_barrier
    v_mfma_f32_32x32x16_bf16 v[64:79], v[236:239], v[228:231], v[64:79]
    ds_read_b128 v[208:211], v2 offset:0
    ds_read_b64_tr_b16 v[216:217], v10 offset:0
    ds_read_b64_tr_b16 v[218:219], v10 offset:768
    v_mfma_f32_32x32x16_bf16 v[80:95], v[236:239], v[232:235], v[80:95]
    ds_read_b128 v[212:215], v2 offset:4096
    ds_read_b64_tr_b16 v[220:221], v10 offset:32
    ds_read_b64_tr_b16 v[222:223], v10 offset:800
    v_mfma_f32_32x32x16_bf16 v[96:111], v[240:243], v[228:231], v[96:111]
    ds_read_b64_tr_b16 v[224:225], v10 offset:64
    ds_read_b64_tr_b16 v[226:227], v10 offset:832
    v_mfma_f32_32x32x16_bf16 v[112:127], v[240:243], v[232:235], v[112:127]
    v_mov_b32 v162, 0
    v_mov_b32 v163, 0
    v_mov_b32 v166, 0
    v_mfma_f32_32x32x16_bf16 v[128:143], v[244:247], v[228:231], v[128:143]
    v_mov_b32 v167, 0
    v_mov_b32 v170, 0
    v_mov_b32 v171, 0
    v_mov_b32 v174, 0
    v_mfma_f32_32x32x16_bf16 v[144:159], v[244:247], v[232:235], v[144:159]
    v_mov_b32 v175, 0
    v_mov_b32 v178, 0
    v_mov_b32 v179, 0
    v_mov_b32 v15, 0
    s_waitcnt lgkmcnt(0)
    v_mfma_f32_32x32x16_bf16 v[64:79], v[216:219], v[208:211], v[64:79]
    ds_read_b128 v[228:231], v3 offset:0
    ds_read_b64_tr_b16 v[236:237], v10 offset:3072
    ds_read_b64_tr_b16 v[238:239], v10 offset:3840
    v_mfma_f32_32x32x16_bf16 v[80:95], v[216:219], v[212:215], v[80:95]
    ds_read_b128 v[232:235], v3 offset:4096
    ds_read_b64_tr_b16 v[240:241], v10 offset:3104
    ds_read_b64_tr_b16 v[242:243], v10 offset:3872
    v_mfma_f32_32x32x16_bf16 v[96:111], v[220:223], v[208:211], v[96:111]
    ds_read_b64_tr_b16 v[244:245], v10 offset:3136
    ds_read_b64_tr_b16 v[246:247], v10 offset:3904
    v_mfma_f32_32x32x16_bf16 v[112:127], v[220:223], v[212:215], v[112:127]
    v_mfma_f32_32x32x16_bf16 v[128:143], v[224:227], v[208:211], v[128:143]
    v_mfma_f32_32x32x16_bf16 v[144:159], v[224:227], v[212:215], v[144:159]
    s_waitcnt lgkmcnt(0)
    v_mfma_f32_32x32x16_bf16 v[64:79], v[236:239], v[228:231], v[64:79]
    ds_read_b128 v[208:211], v4 offset:0
    ds_read_b64_tr_b16 v[216:217], v10 offset:6144
    ds_read_b64_tr_b16 v[218:219], v10 offset:6912
    v_mfma_f32_32x32x16_bf16 v[80:95], v[236:239], v[232:235], v[80:95]
    ds_read_b128 v[212:215], v4 offset:4096
    ds_read_b64_tr_b16 v[220:221], v10 offset:6176
    ds_read_b64_tr_b16 v[222:223], v10 offset:6944
    v_mfma_f32_32x32x16_bf16 v[96:111], v[240:243], v[228:231], v[96:111]
    ds_read_b64_tr_b16 v[224:225], v10 offset:6208
    ds_read_b64_tr_b16 v[226:227], v10 offset:6976
    v_mfma_f32_32x32x16_bf16 v[112:127], v[240:243], v[232:235], v[112:127]
    v_mfma_f32_32x32x16_bf16 v[128:143], v[244:247], v[228:231], v[128:143]
    v_mfma_f32_32x32x16_bf16 v[144:159], v[244:247], v[232:235], v[144:159]
    s_waitcnt lgkmcnt(0)
    v_mfma_f32_32x32x16_bf16 v[64:79], v[216:219], v[208:211], v[64:79]
    ds_read_b128 v[228:231], v5 offset:0
    ds_read_b64_tr_b16 v[236:237], v10 offset:9216
    ds_read_b64_tr_b16 v[238:239], v10 offset:9984
    v_mfma_f32_32x32x16_bf16 v[80:95], v[216:219], v[212:215], v[80:95]
    ds_read_b128 v[232:235], v5 offset:4096
    ds_read_b64_tr_b16 v[240:241], v10 offset:9248
    ds_read_b64_tr_b16 v[242:243], v10 offset:10016
    v_mfma_f32_32x32x16_bf16 v[96:111], v[220:223], v[208:211], v[96:111]
    ds_read_b64_tr_b16 v[244:245], v10 offset:9280
    ds_read_b64_tr_b16 v[246:247], v10 offset:10048
    v_mfma_f32_32x32x16_bf16 v[112:127], v[220:223], v[212:215], v[112:127]
    v_mfma_f32_32x32x16_bf16 v[128:143], v[224:227], v[208:211], v[128:143]
    v_mfma_f32_32x32x16_bf16 v[144:159], v[224:227], v[212:215], v[144:159]
    s_waitcnt lgkmcnt(0)
    s_barrier
    v_mfma_f32_32x32x16_bf16 v[64:79], v[236:239], v[228:231], v[64:79]
    ds_read_b128 v[208:211], v2 offset:41024
    ds_read_b64_tr_b16 v[216:217], v10 offset:41024
    ds_read_b64_tr_b16 v[218:219], v10 offset:41792
    v_mfma_f32_32x32x16_bf16 v[80:95], v[236:239], v[232:235], v[80:95]
    ds_read_b128 v[212:215], v2 offset:45120
    ds_read_b64_tr_b16 v[220:221], v10 offset:41056
    ds_read_b64_tr_b16 v[222:223], v10 offset:41824
    v_mfma_f32_32x32x16_bf16 v[96:111], v[240:243], v[228:231], v[96:111]
    ds_read_b64_tr_b16 v[224:225], v10 offset:41088
    ds_read_b64_tr_b16 v[226:227], v10 offset:41856
    v_mfma_f32_32x32x16_bf16 v[112:127], v[240:243], v[232:235], v[112:127]
    v_mfma_f32_32x32x16_bf16 v[128:143], v[244:247], v[228:231], v[128:143]
    v_mfma_f32_32x32x16_bf16 v[144:159], v[244:247], v[232:235], v[144:159]
    s_waitcnt lgkmcnt(0)
    v_mfma_f32_32x32x16_bf16 v[64:79], v[216:219], v[208:211], v[64:79]
    ds_read_b128 v[228:231], v3 offset:41024
    ds_read_b64_tr_b16 v[236:237], v10 offset:44096
    ds_read_b64_tr_b16 v[238:239], v10 offset:44864
    v_mfma_f32_32x32x16_bf16 v[80:95], v[216:219], v[212:215], v[80:95]
    ds_read_b128 v[232:235], v3 offset:45120
    ds_read_b64_tr_b16 v[240:241], v10 offset:44128
    ds_read_b64_tr_b16 v[242:243], v10 offset:44896
    v_mfma_f32_32x32x16_bf16 v[96:111], v[220:223], v[208:211], v[96:111]
    ds_read_b64_tr_b16 v[244:245], v10 offset:44160
    ds_read_b64_tr_b16 v[246:247], v10 offset:44928
    v_mfma_f32_32x32x16_bf16 v[112:127], v[220:223], v[212:215], v[112:127]
    v_mfma_f32_32x32x16_bf16 v[128:143], v[224:227], v[208:211], v[128:143]
    v_mfma_f32_32x32x16_bf16 v[144:159], v[224:227], v[212:215], v[144:159]
    s_waitcnt lgkmcnt(0)
    v_mfma_f32_32x32x16_bf16 v[64:79], v[236:239], v[228:231], v[64:79]
    ds_read_b128 v[208:211], v4 offset:41024
    ds_read_b64_tr_b16 v[216:217], v10 offset:47168
    ds_read_b64_tr_b16 v[218:219], v10 offset:47936
    v_mfma_f32_32x32x16_bf16 v[80:95], v[236:239], v[232:235], v[80:95]
    ds_read_b128 v[212:215], v4 offset:45120
    ds_read_b64_tr_b16 v[220:221], v10 offset:47200
    ds_read_b64_tr_b16 v[222:223], v10 offset:47968
    v_mfma_f32_32x32x16_bf16 v[96:111], v[240:243], v[228:231], v[96:111]
    ds_read_b64_tr_b16 v[224:225], v10 offset:47232
    ds_read_b64_tr_b16 v[226:227], v10 offset:48000
    v_mfma_f32_32x32x16_bf16 v[112:127], v[240:243], v[232:235], v[112:127]
    v_mfma_f32_32x32x16_bf16 v[128:143], v[244:247], v[228:231], v[128:143]
    v_mfma_f32_32x32x16_bf16 v[144:159], v[244:247], v[232:235], v[144:159]
    s_waitcnt lgkmcnt(0)
    v_mfma_f32_32x32x16_bf16 v[64:79], v[216:219], v[208:211], v[64:79]
    ds_read_b128 v[228:231], v5 offset:41024
    ds_read_b64_tr_b16 v[236:237], v10 offset:50240
    ds_read_b64_tr_b16 v[238:239], v10 offset:51008
    v_mfma_f32_32x32x16_bf16 v[80:95], v[216:219], v[212:215], v[80:95]
    ds_read_b128 v[232:235], v5 offset:45120
    ds_read_b64_tr_b16 v[240:241], v10 offset:50272
    ds_read_b64_tr_b16 v[242:243], v10 offset:51040
    v_mfma_f32_32x32x16_bf16 v[96:111], v[220:223], v[208:211], v[96:111]
    ds_read_b64_tr_b16 v[244:245], v10 offset:50304
    ds_read_b64_tr_b16 v[246:247], v10 offset:51072
    v_mfma_f32_32x32x16_bf16 v[112:127], v[220:223], v[212:215], v[112:127]
    v_mfma_f32_32x32x16_bf16 v[128:143], v[224:227], v[208:211], v[128:143]
    v_mfma_f32_32x32x16_bf16 v[144:159], v[224:227], v[212:215], v[144:159]
    s_waitcnt lgkmcnt(0)
    s_barrier
    v_mfma_f32_32x32x16_bf16 v[64:79], v[236:239], v[228:231], v[64:79]
    ds_read_b128 v[208:211], v6 offset:0
    ds_read_b64_tr_b16 v[216:217], v11 offset:0
    ds_read_b64_tr_b16 v[218:219], v11 offset:768
    v_mfma_f32_32x32x16_bf16 v[80:95], v[236:239], v[232:235], v[80:95]
    ds_read_b128 v[212:215], v6 offset:4096
    ds_read_b64_tr_b16 v[220:221], v11 offset:32
    ds_read_b64_tr_b16 v[222:223], v11 offset:800
    v_mfma_f32_32x32x16_bf16 v[96:111], v[240:243], v[228:231], v[96:111]
    ds_read_b64_tr_b16 v[224:225], v11 offset:64
    ds_read_b64_tr_b16 v[226:227], v11 offset:832
    v_mfma_f32_32x32x16_bf16 v[112:127], v[240:243], v[232:235], v[112:127]
    v_mfma_f32_32x32x16_bf16 v[128:143], v[244:247], v[228:231], v[128:143]
    v_mfma_f32_32x32x16_bf16 v[144:159], v[244:247], v[232:235], v[144:159]
    s_waitcnt lgkmcnt(0)
    v_mfma_f32_32x32x16_bf16 v[64:79], v[216:219], v[208:211], v[64:79]
    ds_read_b128 v[228:231], v7 offset:0
    ds_read_b64_tr_b16 v[236:237], v11 offset:3072
    ds_read_b64_tr_b16 v[238:239], v11 offset:3840
    v_mfma_f32_32x32x16_bf16 v[80:95], v[216:219], v[212:215], v[80:95]
    ds_read_b128 v[232:235], v7 offset:4096
    ds_read_b64_tr_b16 v[240:241], v11 offset:3104
    ds_read_b64_tr_b16 v[242:243], v11 offset:3872
    v_mfma_f32_32x32x16_bf16 v[96:111], v[220:223], v[208:211], v[96:111]
    ds_read_b64_tr_b16 v[244:245], v11 offset:3136
    ds_read_b64_tr_b16 v[246:247], v11 offset:3904
    v_mfma_f32_32x32x16_bf16 v[112:127], v[220:223], v[212:215], v[112:127]
    v_mfma_f32_32x32x16_bf16 v[128:143], v[224:227], v[208:211], v[128:143]
    v_mfma_f32_32x32x16_bf16 v[144:159], v[224:227], v[212:215], v[144:159]
    s_waitcnt lgkmcnt(0)
    v_mfma_f32_32x32x16_bf16 v[64:79], v[236:239], v[228:231], v[64:79]
    ds_read_b128 v[208:211], v8 offset:0
    ds_read_b64_tr_b16 v[216:217], v11 offset:6144
    ds_read_b64_tr_b16 v[218:219], v11 offset:6912
    ds_read_b128 v[212:215], v8 offset:4096
    ds_read_b64_tr_b16 v[220:221], v11 offset:6176
    v_mfma_f32_32x32x16_bf16 v[80:95], v[236:239], v[232:235], v[80:95]
    ds_read_b64_tr_b16 v[222:223], v11 offset:6944
    ds_read_b64_tr_b16 v[224:225], v11 offset:6208
    ds_read_b64_tr_b16 v[226:227], v11 offset:6976
    ds_read_b128 v[16:19], v15 offset:21200
    ds_read_b128 v[36:39], v49 offset:0
    v_mfma_f32_32x32x16_bf16 v[96:111], v[240:243], v[228:231], v[96:111]
    ds_read_b128 v[40:43], v49 offset:512
    ds_read_b64 v[160:161], v48 offset:16896
    ds_read_b64 v[164:165], v48 offset:17408
    ds_read_b64 v[168:169], v48 offset:17920
    v_mfma_f32_32x32x16_bf16 v[112:127], v[240:243], v[232:235], v[112:127]
    v_mfma_f32_32x32x16_bf16 v[128:143], v[244:247], v[228:231], v[128:143]
    v_mfma_f32_32x32x16_bf16 v[144:159], v[244:247], v[232:235], v[144:159]
    s_waitcnt lgkmcnt(0)
    v_mfma_f32_32x32x16_bf16 v[64:79], v[216:219], v[208:211], v[64:79]
    ds_read_b128 v[228:231], v9 offset:0
    ds_read_b64_tr_b16 v[236:237], v11 offset:9216
    ds_read_b64_tr_b16 v[238:239], v11 offset:9984
    v_mfma_f32_32x32x16_bf16 v[80:95], v[216:219], v[212:215], v[80:95]
    ds_read_b128 v[232:235], v9 offset:4096
    ds_read_b64_tr_b16 v[240:241], v11 offset:9248
    ds_read_b64_tr_b16 v[242:243], v11 offset:10016
    v_mfma_f32_32x32x16_bf16 v[96:111], v[220:223], v[208:211], v[96:111]
    ds_read_b64_tr_b16 v[244:245], v11 offset:9280
    ds_read_b64_tr_b16 v[246:247], v11 offset:10048
    v_mfma_f32_32x32x16_bf16 v[112:127], v[220:223], v[212:215], v[112:127]
    v_and_b32 v16, v16, v17
    v_and_b32 v18, v18, v19
    v_mfma_f32_32x32x16_bf16 v[128:143], v[224:227], v[208:211], v[128:143]
    v_and_b32 v16, v16, v18
    s_nop 0
    v_readfirstlane_b32 s95, v16
    v_mov_b32 v172, v39
    v_mfma_f32_32x32x16_bf16 v[144:159], v[224:227], v[212:215], v[144:159]
    v_and_b32 v173, 0xffff, v39
    v_mov_b32 v176, v43
    v_and_b32 v177, 0xffff, v43
    s_waitcnt lgkmcnt(0)
    s_cmp_eq_u32 s95, 0
    s_cbranch_scc1 L_opslow
L_opok:
    v_mfma_f32_32x32x16_bf16 v[64:79], v[236:239], v[228:231], v[64:79]
    v_mov_b32 v14, s100
    v_mfma_f32_32x32x16_bf16 v[64:79], v[160:163], v[172:175], v[64:79]
    v_mov_b32 v15, 1
    v_mfma_f32_32x32x16_bf16 v[80:95], v[236:239], v[232:235], v[80:95]
    ds_write_b32 v14, v15 offset:21152
    v_mfma_f32_32x32x16_bf16 v[80:95], v[160:163], v[176:179], v[80:95]
    v_mfma_f32_32x32x16_bf16 v[96:111], v[240:243], v[228:231], v[96:111]
    v_mfma_f32_32x32x16_bf16 v[96:111], v[164:167], v[172:175], v[96:111]
    v_mfma_f32_32x32x16_bf16 v[112:127], v[240:243], v[232:235], v[112:127]
    v_mfma_f32_32x32x16_bf16 v[112:127], v[164:167], v[176:179], v[112:127]
    v_mfma_f32_32x32x16_bf16 v[128:143], v[244:247], v[228:231], v[128:143]
    v_mfma_f32_32x32x16_bf16 v[128:143], v[168:171], v[172:175], v[128:143]
    v_mfma_f32_32x32x16_bf16 v[144:159], v[244:247], v[232:235], v[144:159]
    v_mfma_f32_32x32x16_bf16 v[144:159], v[168:171], v[176:179], v[144:159]
    s_setprio 3
    v_pk_mul_f32 v[180:181], v[64:65], v[64:65]
    s_nop 1
    v_pk_mul_f32 v[196:197], v[80:81], v[80:81]
    v_pk_mul_f32 v[182:183], v[66:67], v[66:67]
    v_pk_mul_f32 v[198:199], v[82:83], v[82:83]
    v_pk_mul_f32 v[184:185], v[68:69], v[68:69]
    v_pk_mul_f32 v[200:201], v[84:85], v[84:85]
    v_pk_mul_f32 v[186:187], v[70:71], v[70:71]
    v_pk_mul_f32 v[202:203], v[86:87], v[86:87]
    v_pk_fma_f32 v[180:181], v[180:181], v[36:37], v[36:37] op_sel:[0,1,0] op_sel_hi:[1,1,0]
    v_pk_fma_f32 v[196:197], v[196:197], v[40:41], v[40:41] op_sel:[0,1,0] op_sel_hi:[1,1,0]
    v_pk_fma_f32 v[182:183], v[182:183], v[36:37], v[36:37] op_sel:[0,1,0] op_sel_hi:[1,1,0]
    v_pk_fma_f32 v[198:199], v[198:199], v[40:41], v[40:41] op_sel:[0,1,0] op_sel_hi:[1,1,0]
    v_pk_fma_f32 v[184:185], v[184:185], v[36:37], v[36:37] op_sel:[0,1,0] op_sel_hi:[1,1,0]
    v_pk_fma_f32 v[200:201], v[200:201], v[40:41], v[40:41] op_sel:[0,1,0] op_sel_hi:[1,1,0]
    v_pk_fma_f32 v[186:187], v[186:187], v[36:37], v[36:37] op_sel:[0,1,0] op_sel_hi:[1,1,0]
    v_pk_fma_f32 v[202:203], v[202:203], v[40:41], v[40:41] op_sel:[0,1,0] op_sel_hi:[1,1,0]
    v_pk_mul_f32 v[180:181], v[180:181], v[64:65]
    v_pk_mul_f32 v[196:197], v[196:197], v[80:81]
    v_pk_mul_f32 v[182:183], v[182:183], v[66:67]
    v_pk_mul_f32 v[198:199], v[198:199], v[82:83]
    v_pk_mul_f32 v[184:185], v[184:185], v[68:69]
    v_pk_mul_f32 v[200:201], v[200:201], v[84:85]
    v_pk_mul_f32 v[186:187], v[186:187], v[70:71]
    v_pk_mul_f32 v[202:203], v[202:203], v[86:87]
    v_exp_f32 v180, v180
    v_exp_f32 v196, v196
    v_exp_f32 v181, v181
    v_exp_f32 v197, v197
    v_exp_f32 v182, v182
    v_exp_f32 v198, v198
    v_exp_f32 v183, v183
    v_exp_f32 v199, v199
    v_exp_f32 v184, v184
    v_exp_f32 v200, v200
    v_exp_f32 v185, v185
    v_exp_f32 v201, v201
    v_exp_f32 v186, v186
    v_exp_f32 v202, v202
    v_exp_f32 v187, v187
    v_exp_f32 v203, v203
    v_pk_mul_f32 v[188:189], v[64:65], v[72:73]
    v_pk_mul_f32 v[204:205], v[80:81], v[88:89]
    v_pk_mul_f32 v[190:191], v[66:67], v[74:75]
    v_pk_mul_f32 v[206:207], v[82:83], v[90:91]
    v_pk_mul_f32 v[192:193], v[68:69], v[76:77]
    v_pk_mul_f32 v[208:209], v[84:85], v[92:93]
    v_pk_mul_f32 v[194:195], v[70:71], v[78:79]
    v_pk_mul_f32 v[210:211], v[86:87], v[94:95]
    v_pk_fma_f32 v[180:181], v[180:181], v[38:39], v[38:39] op_sel:[0,0,0] op_sel_hi:[1,0,0]
    v_pk_fma_f32 v[196:197], v[196:197], v[42:43], v[42:43] op_sel:[0,0,0] op_sel_hi:[1,0,0]
    v_pk_fma_f32 v[182:183], v[182:183], v[38:39], v[38:39] op_sel:[0,0,0] op_sel_hi:[1,0,0]
    v_pk_fma_f32 v[198:199], v[198:199], v[42:43], v[42:43] op_sel:[0,0,0] op_sel_hi:[1,0,0]
    v_pk_fma_f32 v[184:185], v[184:185], v[38:39], v[38:39] op_sel:[0,0,0] op_sel_hi:[1,0,0]
    v_pk_fma_f32 v[200:201], v[200:201], v[42:43], v[42:43] op_sel:[0,0,0] op_sel_hi:[1,0,0]
    v_pk_fma_f32 v[186:187], v[186:187], v[38:39], v[38:39] op_sel:[0,0,0] op_sel_hi:[1,0,0]
    v_pk_fma_f32 v[202:203], v[202:203], v[42:43], v[42:43] op_sel:[0,0,0] op_sel_hi:[1,0,0]
    v_rcp_f32 v180, v180
    v_rcp_f32 v196, v196
    v_rcp_f32 v181, v181
    v_rcp_f32 v197, v197
    v_rcp_f32 v182, v182
    v_rcp_f32 v198, v198
    v_rcp_f32 v183, v183
    v_rcp_f32 v199, v199
    v_rcp_f32 v184, v184
    v_rcp_f32 v200, v200
    v_rcp_f32 v185, v185
    v_rcp_f32 v201, v201
    v_rcp_f32 v186, v186
    v_rcp_f32 v202, v202
    v_rcp_f32 v187, v187
    v_rcp_f32 v203, v203
    v_pk_mul_f32 v[188:189], v[188:189], v[180:181]
    v_pk_mul_f32 v[204:205], v[204:205], v[196:197]
    v_pk_mul_f32 v[190:191], v[190:191], v[182:183]
    v_pk_mul_f32 v[206:207], v[206:207], v[198:199]
    v_pk_mul_f32 v[192:193], v[192:193], v[184:185]
    v_pk_mul_f32 v[208:209], v[208:209], v[200:201]
    v_pk_mul_f32 v[194:195], v[194:195], v[186:187]
    v_pk_mul_f32 v[210:211], v[210:211], v[202:203]
    v_cvt_pk_bf16_f32 v212, v188, v189
    v_cvt_pk_bf16_f32 v216, v204, v205
    v_cvt_pk_bf16_f32 v213, v190, v191
    v_cvt_pk_bf16_f32 v217, v206, v207
    v_cvt_pk_bf16_f32 v214, v192, v193
    v_cvt_pk_bf16_f32 v218, v208, v209
    v_cvt_pk_bf16_f32 v215, v194, v195
    v_cvt_pk_bf16_f32 v219, v210, v211
    s_cmp_lt_u32 s85, 86
    s_cselect_b32 s78, s84, 0x7ff00000
    s_add_u32 s78, s78, 0
    buffer_store_dwordx4 v[212:215], v12, s[60:63], s78 offen offset:0 sc1
    s_cmp_lt_u32 s85, 86
    s_cselect_b32 s78, s84, 0x7ff00000
    s_add_u32 s78, s78, 88064
    buffer_store_dwordx4 v[216:219], v12, s[60:63], s78 offen offset:0 sc1
    v_pk_mul_f32 v[180:181], v[96:97], v[96:97]
    v_pk_mul_f32 v[196:197], v[112:113], v[112:113]
    v_pk_mul_f32 v[182:183], v[98:99], v[98:99]
    v_pk_mul_f32 v[198:199], v[114:115], v[114:115]
    v_pk_mul_f32 v[184:185], v[100:101], v[100:101]
    v_pk_mul_f32 v[200:201], v[116:117], v[116:117]
    v_pk_mul_f32 v[186:187], v[102:103], v[102:103]
    v_pk_mul_f32 v[202:203], v[118:119], v[118:119]
    v_pk_fma_f32 v[180:181], v[180:181], v[36:37], v[36:37] op_sel:[0,1,0] op_sel_hi:[1,1,0]
    v_pk_fma_f32 v[196:197], v[196:197], v[40:41], v[40:41] op_sel:[0,1,0] op_sel_hi:[1,1,0]
    v_pk_fma_f32 v[182:183], v[182:183], v[36:37], v[36:37] op_sel:[0,1,0] op_sel_hi:[1,1,0]
    v_pk_fma_f32 v[198:199], v[198:199], v[40:41], v[40:41] op_sel:[0,1,0] op_sel_hi:[1,1,0]
    v_pk_fma_f32 v[184:185], v[184:185], v[36:37], v[36:37] op_sel:[0,1,0] op_sel_hi:[1,1,0]
    v_pk_fma_f32 v[200:201], v[200:201], v[40:41], v[40:41] op_sel:[0,1,0] op_sel_hi:[1,1,0]
    v_pk_fma_f32 v[186:187], v[186:187], v[36:37], v[36:37] op_sel:[0,1,0] op_sel_hi:[1,1,0]
    v_pk_fma_f32 v[202:203], v[202:203], v[40:41], v[40:41] op_sel:[0,1,0] op_sel_hi:[1,1,0]
    v_pk_mul_f32 v[180:181], v[180:181], v[96:97]
    v_pk_mul_f32 v[196:197], v[196:197], v[112:113]
    v_pk_mul_f32 v[182:183], v[182:183], v[98:99]
    v_pk_mul_f32 v[198:199], v[198:199], v[114:115]
    v_pk_mul_f32 v[184:185], v[184:185], v[100:101]
    v_pk_mul_f32 v[200:201], v[200:201], v[116:117]
    v_pk_mul_f32 v[186:187], v[186:187], v[102:103]
    v_pk_mul_f32 v[202:203], v[202:203], v[118:119]
    v_exp_f32 v180, v180
    v_exp_f32 v196, v196
    v_exp_f32 v181, v181
    v_exp_f32 v197, v197
    v_exp_f32 v182, v182
    v_exp_f32 v198, v198
    v_exp_f32 v183, v183
    v_exp_f32 v199, v199
    v_exp_f32 v184, v184
    v_exp_f32 v200, v200
    v_exp_f32 v185, v185
    v_exp_f32 v201, v201
    v_exp_f32 v186, v186
    v_exp_f32 v202, v202
    v_exp_f32 v187, v187
    v_exp_f32 v203, v203
    v_pk_mul_f32 v[188:189], v[96:97], v[104:105]
    v_pk_mul_f32 v[204:205], v[112:113], v[120:121]
    v_pk_mul_f32 v[190:191], v[98:99], v[106:107]
    v_pk_mul_f32 v[206:207], v[114:115], v[122:123]
    v_pk_mul_f32 v[192:193], v[100:101], v[108:109]
    v_pk_mul_f32 v[208:209], v[116:117], v[124:125]
    v_pk_mul_f32 v[194:195], v[102:103], v[110:111]
    v_pk_mul_f32 v[210:211], v[118:119], v[126:127]
    v_pk_fma_f32 v[180:181], v[180:181], v[38:39], v[38:39] op_sel:[0,0,0] op_sel_hi:[1,0,0]
    v_pk_fma_f32 v[196:197], v[196:197], v[42:43], v[42:43] op_sel:[0,0,0] op_sel_hi:[1,0,0]
    v_pk_fma_f32 v[182:183], v[182:183], v[38:39], v[38:39] op_sel:[0,0,0] op_sel_hi:[1,0,0]
    v_pk_fma_f32 v[198:199], v[198:199], v[42:43], v[42:43] op_sel:[0,0,0] op_sel_hi:[1,0,0]
    v_pk_fma_f32 v[184:185], v[184:185], v[38:39], v[38:39] op_sel:[0,0,0] op_sel_hi:[1,0,0]
    v_pk_fma_f32 v[200:201], v[200:201], v[42:43], v[42:43] op_sel:[0,0,0] op_sel_hi:[1,0,0]
    v_pk_fma_f32 v[186:187], v[186:187], v[38:39], v[38:39] op_sel:[0,0,0] op_sel_hi:[1,0,0]
    v_pk_fma_f32 v[202:203], v[202:203], v[42:43], v[42:43] op_sel:[0,0,0] op_sel_hi:[1,0,0]
    v_rcp_f32 v180, v180
    v_rcp_f32 v196, v196
    v_rcp_f32 v181, v181
    v_rcp_f32 v197, v197
    v_rcp_f32 v182, v182
    v_rcp_f32 v198, v198
    v_rcp_f32 v183, v183
    v_rcp_f32 v199, v199
    v_rcp_f32 v184, v184
    v_rcp_f32 v200, v200
    v_rcp_f32 v185, v185
    v_rcp_f32 v201, v201
    v_rcp_f32 v186, v186
    v_rcp_f32 v202, v202
    v_rcp_f32 v187, v187
    v_rcp_f32 v203, v203
    v_pk_mul_f32 v[188:189], v[188:189], v[180:181]
    v_pk_mul_f32 v[204:205], v[204:205], v[196:197]
    v_pk_mul_f32 v[190:191], v[190:191], v[182:183]
    v_pk_mul_f32 v[206:207], v[206:207], v[198:199]
    v_pk_mul_f32 v[192:193], v[192:193], v[184:185]
    v_pk_mul_f32 v[208:209], v[208:209], v[200:201]
    v_pk_mul_f32 v[194:195], v[194:195], v[186:187]
    v_pk_mul_f32 v[210:211], v[210:211], v[202:203]
    v_cvt_pk_bf16_f32 v220, v188, v189
    v_cvt_pk_bf16_f32 v224, v204, v205
    v_cvt_pk_bf16_f32 v221, v190, v191
    v_cvt_pk_bf16_f32 v225, v206, v207
    v_cvt_pk_bf16_f32 v222, v192, v193
    v_cvt_pk_bf16_f32 v226, v208, v209
    v_cvt_pk_bf16_f32 v223, v194, v195
    v_cvt_pk_bf16_f32 v227, v210, v211
    s_cmp_lt_u32 s85, 85
    s_cselect_b32 s78, s84, 0x7ff00000
    s_add_u32 s78, s78, 0
    buffer_store_dwordx4 v[220:223], v12, s[60:63], s78 offen offset:1024 sc1
    s_cmp_lt_u32 s85, 85
    s_cselect_b32 s78, s84, 0x7ff00000
    s_add_u32 s78, s78, 88064
    buffer_store_dwordx4 v[224:227], v12, s[60:63], s78 offen offset:1024 sc1
    v_pk_mul_f32 v[180:181], v[128:129], v[128:129]
    v_pk_mul_f32 v[196:197], v[144:145], v[144:145]
    v_pk_mul_f32 v[182:183], v[130:131], v[130:131]
    v_pk_mul_f32 v[198:199], v[146:147], v[146:147]
    v_pk_mul_f32 v[184:185], v[132:133], v[132:133]
    v_pk_mul_f32 v[200:201], v[148:149], v[148:149]
    v_pk_mul_f32 v[186:187], v[134:135], v[134:135]
    v_pk_mul_f32 v[202:203], v[150:151], v[150:151]
    v_pk_fma_f32 v[180:181], v[180:181], v[36:37], v[36:37] op_sel:[0,1,0] op_sel_hi:[1,1,0]
    v_pk_fma_f32 v[196:197], v[196:197], v[40:41], v[40:41] op_sel:[0,1,0] op_sel_hi:[1,1,0]
    v_pk_fma_f32 v[182:183], v[182:183], v[36:37], v[36:37] op_sel:[0,1,0] op_sel_hi:[1,1,0]
    v_pk_fma_f32 v[198:199], v[198:199], v[40:41], v[40:41] op_sel:[0,1,0] op_sel_hi:[1,1,0]
    v_pk_fma_f32 v[184:185], v[184:185], v[36:37], v[36:37] op_sel:[0,1,0] op_sel_hi:[1,1,0]
    v_pk_fma_f32 v[200:201], v[200:201], v[40:41], v[40:41] op_sel:[0,1,0] op_sel_hi:[1,1,0]
    v_pk_fma_f32 v[186:187], v[186:187], v[36:37], v[36:37] op_sel:[0,1,0] op_sel_hi:[1,1,0]
    v_pk_fma_f32 v[202:203], v[202:203], v[40:41], v[40:41] op_sel:[0,1,0] op_sel_hi:[1,1,0]
    v_pk_mul_f32 v[180:181], v[180:181], v[128:129]
    v_pk_mul_f32 v[196:197], v[196:197], v[144:145]
    v_pk_mul_f32 v[182:183], v[182:183], v[130:131]
    v_pk_mul_f32 v[198:199], v[198:199], v[146:147]
    v_pk_mul_f32 v[184:185], v[184:185], v[132:133]
    v_pk_mul_f32 v[200:201], v[200:201], v[148:149]
    v_pk_mul_f32 v[186:187], v[186:187], v[134:135]
    v_pk_mul_f32 v[202:203], v[202:203], v[150:151]
    v_exp_f32 v180, v180
    v_exp_f32 v196, v196
    v_exp_f32 v181, v181
    v_exp_f32 v197, v197
    v_exp_f32 v182, v182
    v_exp_f32 v198, v198
    v_exp_f32 v183, v183
    v_exp_f32 v199, v199
    v_exp_f32 v184, v184
    v_exp_f32 v200, v200
    v_exp_f32 v185, v185
    v_exp_f32 v201, v201
    v_exp_f32 v186, v186
    v_exp_f32 v202, v202
    v_exp_f32 v187, v187
    v_exp_f32 v203, v203
    v_pk_mul_f32 v[188:189], v[128:129], v[136:137]
    v_pk_mul_f32 v[204:205], v[144:145], v[152:153]
    v_pk_mul_f32 v[190:191], v[130:131], v[138:139]
    v_pk_mul_f32 v[206:207], v[146:147], v[154:155]
    v_pk_mul_f32 v[192:193], v[132:133], v[140:141]
    v_pk_mul_f32 v[208:209], v[148:149], v[156:157]
    v_pk_mul_f32 v[194:195], v[134:135], v[142:143]
    v_pk_mul_f32 v[210:211], v[150:151], v[158:159]
    v_pk_fma_f32 v[180:181], v[180:181], v[38:39], v[38:39] op_sel:[0,0,0] op_sel_hi:[1,0,0]
    v_pk_fma_f32 v[196:197], v[196:197], v[42:43], v[42:43] op_sel:[0,0,0] op_sel_hi:[1,0,0]
    v_pk_fma_f32 v[182:183], v[182:183], v[38:39], v[38:39] op_sel:[0,0,0] op_sel_hi:[1,0,0]
    v_pk_fma_f32 v[198:199], v[198:199], v[42:43], v[42:43] op_sel:[0,0,0] op_sel_hi:[1,0,0]
    v_pk_fma_f32 v[184:185], v[184:185], v[38:39], v[38:39] op_sel:[0,0,0] op_sel_hi:[1,0,0]
    v_pk_fma_f32 v[200:201], v[200:201], v[42:43], v[42:43] op_sel:[0,0,0] op_sel_hi:[1,0,0]
    v_pk_fma_f32 v[186:187], v[186:187], v[38:39], v[38:39] op_sel:[0,0,0] op_sel_hi:[1,0,0]
    v_pk_fma_f32 v[202:203], v[202:203], v[42:43], v[42:43] op_sel:[0,0,0] op_sel_hi:[1,0,0]
    v_rcp_f32 v180, v180
    v_rcp_f32 v196, v196
    v_rcp_f32 v181, v181
    v_rcp_f32 v197, v197
    v_rcp_f32 v182, v182
    v_rcp_f32 v198, v198
    v_rcp_f32 v183, v183
    v_rcp_f32 v199, v199
    v_rcp_f32 v184, v184
    v_rcp_f32 v200, v200
    v_rcp_f32 v185, v185
    v_rcp_f32 v201, v201
    v_rcp_f32 v186, v186
    v_rcp_f32 v202, v202
    v_rcp_f32 v187, v187
    v_rcp_f32 v203, v203
    v_pk_mul_f32 v[188:189], v[188:189], v[180:181]
    v_pk_mul_f32 v[204:205], v[204:205], v[196:197]
    v_pk_mul_f32 v[190:191], v[190:191], v[182:183]
    v_pk_mul_f32 v[206:207], v[206:207], v[198:199]
    v_pk_mul_f32 v[192:193], v[192:193], v[184:185]
    v_pk_mul_f32 v[208:209], v[208:209], v[200:201]
    v_pk_mul_f32 v[194:195], v[194:195], v[186:187]
    v_pk_mul_f32 v[210:211], v[210:211], v[202:203]
    v_cvt_pk_bf16_f32 v212, v188, v189
    v_cvt_pk_bf16_f32 v216, v204, v205
    v_cvt_pk_bf16_f32 v213, v190, v191
    v_cvt_pk_bf16_f32 v217, v206, v207
    v_cvt_pk_bf16_f32 v214, v192, v193
    v_cvt_pk_bf16_f32 v218, v208, v209
    v_cvt_pk_bf16_f32 v215, v194, v195
    v_cvt_pk_bf16_f32 v219, v210, v211
    s_cmp_lt_u32 s85, 84
    s_cselect_b32 s78, s84, 0x7ff00000
    s_add_u32 s78, s78, 0
    buffer_store_dwordx4 v[212:215], v12, s[60:63], s78 offen offset:2048 sc1
    s_cmp_lt_u32 s85, 84
    s_cselect_b32 s78, s84, 0x7ff00000
    s_add_u32 s78, s78, 88064
    buffer_store_dwordx4 v[216:219], v12, s[60:63], s78 offen offset:2048 sc1
L_gdone:
    v_mov_b32 v14, s100
    v_mov_b32 v15, 1
    ds_write_b32 v14, v15 offset:21088
    v_mov_b32 v14, 0
    s_mov_b32 s94, 0x400000
L_lw_3:
    ds_read_b128 v[32:35], v14 offset:21024
    s_waitcnt lgkmcnt(0)
    v_and_b32 v32, v32, v33
    v_and_b32 v34, v34, v35
    v_and_b32 v32, v32, v34
    s_nop 0
    v_readfirstlane_b32 s95, v32
    s_nop 0
    s_cmp_lg_u32 s95, 0
    s_cbranch_scc1 L_lwd_4
    s_sleep 1
    s_sub_u32 s94, s94, 1
    s_cbranch_scc0 L_lw_3
L_lwd_4:
    ds_read_b64_tr_b16 v[64:65], v50 offset:40768
    ds_read_b64_tr_b16 v[66:67], v50 offset:41792
    ds_read_b64_tr_b16 v[68:69], v51 offset:40768
    ds_read_b64_tr_b16 v[70:71], v51 offset:41792
    ds_read_b64_tr_b16 v[72:73], v50 offset:44864
    ds_read_b64_tr_b16 v[74:75], v50 offset:45888
    ds_read_b64_tr_b16 v[76:77], v51 offset:44864
    ds_read_b64_tr_b16 v[78:79], v51 offset:45888
    ds_read_b64_tr_b16 v[80:81], v50 offset:48960
    ds_read_b64_tr_b16 v[82:83], v50 offset:49984
    ds_read_b64_tr_b16 v[84:85], v51 offset:48960
    ds_read_b64_tr_b16 v[86:87], v51 offset:49984
    ds_read_b64_tr_b16 v[88:89], v50 offset:53056
    ds_read_b64_tr_b16 v[90:91], v50 offset:54080
    ds_read_b64_tr_b16 v[92:93], v51 offset:53056
    ds_read_b64_tr_b16 v[94:95], v51 offset:54080
    ds_read_b64_tr_b16 v[160:161], v50 offset:57152
    ds_read_b64_tr_b16 v[162:163], v50 offset:58176
    ds_read_b64_tr_b16 v[164:165], v51 offset:57152
    ds_read_b64_tr_b16 v[166:167], v51 offset:58176
    ds_read_b64_tr_b16 v[168:169], v50 offset:61248
    ds_read_b64_tr_b16 v[170:171], v50 offset:62272
    ds_read_b64_tr_b16 v[172:173], v51 offset:61248
    ds_read_b64_tr_b16 v[174:175], v51 offset:62272
    ds_read_b64_tr_b16 v[228:229], v50 offset:65344
    ds_read_b64_tr_b16 v[230:231], v52 offset:832
    ds_read_b64_tr_b16 v[232:233], v51 offset:65344
    ds_read_b64_tr_b16 v[234:235], v53 offset:832
    ds_read_b64_tr_b16 v[236:237], v52 offset:3904
    ds_read_b64_tr_b16 v[238:239], v52 offset:4928
    ds_read_b64_tr_b16 v[240:241], v53 offset:3904
    ds_read_b64_tr_b16 v[242:243], v53 offset:4928
    ds_read_b64_tr_b16 v[244:245], v52 offset:8000
    ds_read_b64_tr_b16 v[246:247], v52 offset:9024
    ds_read_b64_tr_b16 v[248:249], v53 offset:8000
    ds_read_b64_tr_b16 v[250:251], v53 offset:9024
    ds_read_b64_tr_b16 v[16:17], v52 offset:12096
    ds_read_b64_tr_b16 v[18:19], v52 offset:13120
    ds_read_b64_tr_b16 v[20:21], v53 offset:12096
    ds_read_b64_tr_b16 v[22:23], v53 offset:13120
    ds_read_b64_tr_b16 v[24:25], v52 offset:16192
    ds_read_b64_tr_b16 v[26:27], v52 offset:17216
    ds_read_b64_tr_b16 v[28:29], v53 offset:16192
    ds_read_b64_tr_b16 v[30:31], v53 offset:17216
    ds_read_b64_tr_b16 v[56:57], v52 offset:20288
    ds_read_b64_tr_b16 v[58:59], v52 offset:21312
    ds_read_b64_tr_b16 v[60:61], v53 offset:20288
    ds_read_b64_tr_b16 v[62:63], v53 offset:21312
    s_waitcnt vmcnt(0)
    buffer_store_dword v45, off, s[60:63], s81 sc1
    s_waitcnt lgkmcnt(0)
    v_mov_b32 v14, s100
    v_mov_b32 v15, 1
    ds_write_b32 v14, v15 offset:21040
    v_mov_b32 v14, 0
    s_mov_b32 s94, 0x400000
L_lw_5:
    ds_read_b128 v[32:35], v14 offset:21040
    s_waitcnt lgkmcnt(0)
    v_and_b32 v32, v32, v33
    v_and_b32 v34, v34, v35
    v_and_b32 v32, v32, v34
    s_nop 0
    v_readfirstlane_b32 s95, v32
    s_nop 0
    s_cmp_lg_u32 s95, 0
    s_cbranch_scc1 L_lwd_6
    s_sleep 1
    s_sub_u32 s94, s94, 1
    s_cbranch_scc0 L_lw_5
L_lwd_6:
    s_add_u32 m0, s76, 40768
    s_add_u32 s78, s77, 983040
    buffer_load_dwordx4 v13, s[56:59], s78 offen lds
    s_add_u32 m0, s76, 44864
    s_add_u32 s78, s77, 1015808
    buffer_load_dwordx4 v13, s[56:59], s78 offen lds
    s_add_u32 m0, s76, 48960
    s_add_u32 s78, s77, 1048576
    buffer_load_dwordx4 v13, s[56:59], s78 offen lds
    s_add_u32 m0, s76, 53056
    s_add_u32 s78, s77, 1081344
    buffer_load_dwordx4 v13, s[56:59], s78 offen lds
    s_add_u32 m0, s76, 57152
    s_add_u32 s78, s77, 1114112
    buffer_load_dwordx4 v13, s[56:59], s78 offen lds
    s_add_u32 m0, s76, 61248
    s_add_u32 s78, s77, 1146880
    buffer_load_dwordx4 v13, s[56:59], s78 offen lds
    s_add_u32 m0, s76, 65344
    s_add_u32 s78, s77, 1179648
    buffer_load_dwordx4 v13, s[56:59], s78 offen lds
    s_add_u32 m0, s76, 69440
    s_add_u32 s78, s77, 1212416
    buffer_load_dwordx4 v13, s[56:59], s78 offen lds
    s_add_u32 m0, s76, 73536
    s_add_u32 s78, s77, 1245184
    buffer_load_dwordx4 v13, s[56:59], s78 offen lds
    s_add_u32 m0, s76, 77632
    s_add_u32 s78, s77, 1277952
    buffer_load_dwordx4 v13, s[56:59], s78 offen lds
    s_add_u32 m0, s76, 81728
    s_add_u32 s78, s77, 1310720
    buffer_load_dwordx4 v13, s[56:59], s78 offen lds
    s_add_u32 m0, s76, 85824
    s_add_u32 s78, s77, 1343488
    buffer_load_dwordx4 v13, s[56:59], s78 offen lds
    v_lshrrev_b32 v132, 3, v0
    v_and_b32 v133, 7, v0
    v_lshlrev_b32 v133, 4, v133
    v_lshl_add_u32 v132, v132, 10, v133
    s_lshl_b32 s74, s91, 16
    s_lshl_b32 s75, s92, 7
    s_add_u32 s74, s74, s75
    v_add_u32 v132, s74, v132
    global_load_dwordx4 v[128:131], v132, s[16:17]
    buffer_load_dword v36, v47, s[60:63], s82 offen sc1
    s_waitcnt vmcnt(0)
    v_mov_b32 v14, s100
    v_mov_b32 v15, 1
    ds_write_b32 v14, v15 offset:21120
    s_mov_b32 s94, 20000
L_chk_7:
    v_xor_b32 v32, s69, v36
    v_cmp_ne_u32 vcc, 0, v32
    s_nop 1
    s_cbranch_vccz L_ok_8
    s_sub_u32 s94, s94, 1
    s_cbranch_scc1 L_ok_8
    s_sleep 1
    buffer_load_dword v36, v47, s[60:63], s82 offen sc1
    s_waitcnt vmcnt(0)
    s_branch L_chk_7
L_ok_8:
    buffer_load_dwordx4 v[176:179], v12, s[60:63], s79 offen sc1
    s_add_u32 s79, s79, 2048
    buffer_load_dwordx4 v[180:183], v12, s[60:63], s79 offen sc1
    s_add_u32 s79, s79, 2048
    buffer_load_dwordx4 v[184:187], v12, s[60:63], s79 offen sc1
    s_add_u32 s79, s79, 2048
    buffer_load_dwordx4 v[188:191], v12, s[60:63], s79 offen sc1
    s_add_u32 s79, s79, 2048
    buffer_load_dwordx4 v[192:195], v12, s[60:63], s79 offen sc1
    s_add_u32 s79, s79, 2048
    buffer_load_dwordx4 v[196:199], v12, s[60:63], s79 offen sc1
    s_add_u32 s79, s79, 2048
    buffer_load_dwordx4 v[200:203], v12, s[60:63], s79 offen sc1
    s_add_u32 s79, s79, 2048
    buffer_load_dwordx4 v[204:207], v12, s[60:63], s79 offen sc1
    s_add_u32 s79, s79, 2048
    buffer_load_dwordx4 v[208:211], v12, s[60:63], s79 offen sc1
    s_add_u32 s79, s79, 2048
    buffer_load_dwordx4 v[212:215], v12, s[60:63], s79 offen sc1
    s_add_u32 s79, s79, 2048
    buffer_load_dwordx4 v[216:219], v12, s[60:63], s79 offen sc1
    s_add_u32 s79, s79, 2048
    buffer_load_dwordx4 v[220:223], v12, s[60:63], s79 offen sc1
    s_add_u32 s79, s79, 2048
    v_mov_b32 v14, 0
    s_mov_b32 s94, 0x400000
L_lw_9:
    ds_read_b128 v[32:35], v14 offset:21104
    s_waitcnt lgkmcnt(0)
    v_and_b32 v32, v32, v33
    v_and_b32 v34, v34, v35
    v_and_b32 v32, v32, v34
    s_nop 0
    v_readfirstlane_b32 s95, v32
    s_nop 0
    s_cmp_lg_u32 s95, 0
    s_cbranch_scc1 L_lwd_10
    s_sleep 1
    s_sub_u32 s94, s94, 1
    s_cbranch_scc0 L_lw_9
L_lwd_10:
    v_mov_b32 v14, 0
    s_mov_b32 s94, 0x400000
L_lw_11:
    ds_read_b128 v[32:35], v14 offset:21120
    s_waitcnt lgkmcnt(0)
    v_and_b32 v32, v32, v33
    v_and_b32 v34, v34, v35
    v_and_b32 v32, v32, v34
    s_nop 0
    v_readfirstlane_b32 s95, v32
    s_nop 0
    s_cmp_lg_u32 s95, 0
    s_cbranch_scc1 L_lwd_12
    s_sleep 1
    s_sub_u32 s94, s94, 1
    s_cbranch_scc0 L_lw_11
L_lwd_12:
    s_setprio 0
    s_waitcnt vmcnt(11)
    v_mfma_f32_32x32x16_bf16 v[96:111], v[64:67], v[176:179], 0
    buffer_load_dwordx4 v[224:227], v12, s[60:63], s79 offen sc1
    s_add_u32 s79, s79, 2048
    v_mfma_f32_32x32x16_bf16 v[112:127], v[68:71], v[176:179], 0
    s_waitcnt vmcnt(11)
    v_mfma_f32_32x32x16_bf16 v[96:111], v[72:75], v[180:183], v[96:111]
    buffer_load_dwordx4 v[176:179], v12, s[60:63], s79 offen sc1
    s_add_u32 s79, s79, 2048
    v_mfma_f32_32x32x16_bf16 v[112:127], v[76:79], v[180:183], v[112:127]
    s_waitcnt vmcnt(11)
    v_mfma_f32_32x32x16_bf16 v[96:111], v[80:83], v[184:187], v[96:111]
    buffer_load_dwordx4 v[180:183], v12, s[60:63], s79 offen sc1
    s_add_u32 s79, s79, 2048
    v_mfma_f32_32x32x16_bf16 v[112:127], v[84:87], v[184:187], v[112:127]
    s_waitcnt vmcnt(11)
    v_mfma_f32_32x32x16_bf16 v[96:111], v[88:91], v[188:191], v[96:111]
    buffer_load_dwordx4 v[184:187], v12, s[60:63], s79 offen sc1
    s_add_u32 s79, s79, 2048
    v_mfma_f32_32x32x16_bf16 v[112:127], v[92:95], v[188:191], v[112:127]
    s_waitcnt vmcnt(11)
    v_mfma_f32_32x32x16_bf16 v[96:111], v[160:163], v[192:195], v[96:111]
    buffer_load_dwordx4 v[188:191], v12, s[60:63], s79 offen sc1
    s_add_u32 s79, s79, 2048
    v_mfma_f32_32x32x16_bf16 v[112:127], v[164:167], v[192:195], v[112:127]
    s_waitcnt vmcnt(11)
    v_mfma_f32_32x32x16_bf16 v[96:111], v[168:171], v[196:199], v[96:111]
    buffer_load_dwordx4 v[192:195], v12, s[60:63], s79 offen sc1
    s_add_u32 s79, s79, 2048
    v_mfma_f32_32x32x16_bf16 v[112:127], v[172:175], v[196:199], v[112:127]
    s_waitcnt vmcnt(11)
    v_mfma_f32_32x32x16_bf16 v[96:111], v[228:231], v[200:203], v[96:111]
    buffer_load_dwordx4 v[196:199], v12, s[60:63], s79 offen sc1
    s_add_u32 s79, s79, 2048
    v_mfma_f32_32x32x16_bf16 v[112:127], v[232:235], v[200:203], v[112:127]
    s_waitcnt vmcnt(11)
    v_mfma_f32_32x32x16_bf16 v[96:111], v[236:239], v[204:207], v[96:111]
    buffer_load_dwordx4 v[200:203], v12, s[60:63], s79 offen sc1
    s_add_u32 s79, s79, 2048
    v_mfma_f32_32x32x16_bf16 v[112:127], v[240:243], v[204:207], v[112:127]
    s_waitcnt vmcnt(11)
    v_mfma_f32_32x32x16_bf16 v[96:111], v[244:247], v[208:211], v[96:111]
    buffer_load_dwordx4 v[204:207], v12, s[60:63], s79 offen sc1
    s_add_u32 s79, s79, 2048
    v_mfma_f32_32x32x16_bf16 v[112:127], v[248:251], v[208:211], v[112:127]
    s_waitcnt vmcnt(11)
    v_mfma_f32_32x32x16_bf16 v[96:111], v[16:19], v[212:215], v[96:111]
    buffer_load_dwordx4 v[208:211], v12, s[60:63], s79 offen sc1
    s_add_u32 s79, s79, 2048
    v_mfma_f32_32x32x16_bf16 v[112:127], v[20:23], v[212:215], v[112:127]
    s_waitcnt vmcnt(11)
    v_mfma_f32_32x32x16_bf16 v[96:111], v[24:27], v[216:219], v[96:111]
    buffer_load_dwordx4 v[212:215], v12, s[60:63], s79 offen sc1
    s_add_u32 s79, s79, 2048
    v_mfma_f32_32x32x16_bf16 v[112:127], v[28:31], v[216:219], v[112:127]
    s_waitcnt vmcnt(11)
    v_mfma_f32_32x32x16_bf16 v[96:111], v[56:59], v[220:223], v[96:111]
    ds_read_b64_tr_b16 v[64:65], v52 offset:24384
    ds_read_b64_tr_b16 v[66:67], v52 offset:25408
    ds_read_b64_tr_b16 v[68:69], v53 offset:24384
    ds_read_b64_tr_b16 v[70:71], v53 offset:25408
    buffer_load_dwordx4 v[216:219], v12, s[60:63], s79 offen sc1
    s_add_u32 s79, s79, 2048
    v_mfma_f32_32x32x16_bf16 v[112:127], v[60:63], v[220:223], v[112:127]
    s_waitcnt lgkmcnt(0) vmcnt(11)
    v_mfma_f32_32x32x16_bf16 v[96:111], v[64:67], v[224:227], v[96:111]
    ds_read_b64_tr_b16 v[72:73], v52 offset:28480
    ds_read_b64_tr_b16 v[74:75], v52 offset:29504
    ds_read_b64_tr_b16 v[76:77], v53 offset:28480
    ds_read_b64_tr_b16 v[78:79], v53 offset:29504
    buffer_load_dwordx4 v[220:223], v12, s[60:63], s79 offen sc1
    s_add_u32 s79, s79, 2048
    v_mfma_f32_32x32x16_bf16 v[112:127], v[68:71], v[224:227], v[112:127]
    s_waitcnt lgkmcnt(0) vmcnt(11)
    v_mfma_f32_32x32x16_bf16 v[96:111], v[72:75], v[176:179], v[96:111]
    ds_read_b64_tr_b16 v[64:65], v52 offset:32576
    ds_read_b64_tr_b16 v[66:67], v52 offset:33600
    ds_read_b64_tr_b16 v[68:69], v53 offset:32576
    ds_read_b64_tr_b16 v[70:71], v53 offset:33600
    buffer_load_dwordx4 v[224:227], v12, s[60:63], s79 offen sc1
    s_add_u32 s79, s79, 2048
    v_mfma_f32_32x32x16_bf16 v[112:127], v[76:79], v[176:179], v[112:127]
    s_waitcnt lgkmcnt(0) vmcnt(11)
    v_mfma_f32_32x32x16_bf16 v[96:111], v[64:67], v[180:183], v[96:111]
    ds_read_b64_tr_b16 v[72:73], v52 offset:36672
    ds_read_b64_tr_b16 v[74:75], v52 offset:37696
    ds_read_b64_tr_b16 v[76:77], v53 offset:36672
    ds_read_b64_tr_b16 v[78:79], v53 offset:37696
    buffer_load_dwordx4 v[176:179], v12, s[60:63], s79 offen sc1
    s_add_u32 s79, s79, 2048
    v_mfma_f32_32x32x16_bf16 v[112:127], v[68:71], v[180:183], v[112:127]
    s_waitcnt lgkmcnt(0) vmcnt(11)
    v_mfma_f32_32x32x16_bf16 v[96:111], v[72:75], v[184:187], v[96:111]
    ds_read_b64_tr_b16 v[64:65], v52 offset:40768
    ds_read_b64_tr_b16 v[66:67], v52 offset:41792
    ds_read_b64_tr_b16 v[68:69], v53 offset:40768
    ds_read_b64_tr_b16 v[70:71], v53 offset:41792
    buffer_load_dwordx4 v[180:183], v12, s[60:63], s79 offen sc1
    s_add_u32 s79, s79, 2048
    v_mfma_f32_32x32x16_bf16 v[112:127], v[76:79], v[184:187], v[112:127]
    s_waitcnt lgkmcnt(0) vmcnt(11)
    v_mfma_f32_32x32x16_bf16 v[96:111], v[64:67], v[188:191], v[96:111]
    ds_read_b64_tr_b16 v[72:73], v52 offset:44864
    ds_read_b64_tr_b16 v[74:75], v52 offset:45888
    ds_read_b64_tr_b16 v[76:77], v53 offset:44864
    ds_read_b64_tr_b16 v[78:79], v53 offset:45888
    buffer_load_dwordx4 v[184:187], v12, s[60:63], s79 offen sc1
    s_add_u32 s79, s79, 2048
    v_mfma_f32_32x32x16_bf16 v[112:127], v[68:71], v[188:191], v[112:127]
    s_waitcnt lgkmcnt(0) vmcnt(11)
    v_mfma_f32_32x32x16_bf16 v[96:111], v[72:75], v[192:195], v[96:111]
    ds_read_b64_tr_b16 v[64:65], v52 offset:48960
    ds_read_b64_tr_b16 v[66:67], v52 offset:49984
    ds_read_b64_tr_b16 v[68:69], v53 offset:48960
    ds_read_b64_tr_b16 v[70:71], v53 offset:49984
    buffer_load_dwordx4 v[188:191], v12, s[60:63], s79 offen sc1
    s_add_u32 s79, s79, 2048
    v_mfma_f32_32x32x16_bf16 v[112:127], v[76:79], v[192:195], v[112:127]
    v_mov_b32 v14, s100
    v_mov_b32 v15, 1
    ds_write_b32 v14, v15 offset:21136
    s_waitcnt lgkmcnt(0) vmcnt(11)
    v_mfma_f32_32x32x16_bf16 v[96:111], v[64:67], v[196:199], v[96:111]
    ds_read_b64_tr_b16 v[72:73], v52 offset:53056
    ds_read_b64_tr_b16 v[74:75], v52 offset:54080
    ds_read_b64_tr_b16 v[76:77], v53 offset:53056
    ds_read_b64_tr_b16 v[78:79], v53 offset:54080
    buffer_load_dwordx4 v[192:195], v12, s[60:63], s79 offen sc1
    s_add_u32 s79, s79, 2048
    v_mfma_f32_32x32x16_bf16 v[112:127], v[68:71], v[196:199], v[112:127]
    s_waitcnt lgkmcnt(0) vmcnt(11)
    v_mfma_f32_32x32x16_bf16 v[96:111], v[72:75], v[200:203], v[96:111]
    ds_read_b64_tr_b16 v[64:65], v52 offset:57152
    ds_read_b64_tr_b16 v[66:67], v52 offset:58176
    ds_read_b64_tr_b16 v[68:69], v53 offset:57152
    ds_read_b64_tr_b16 v[70:71], v53 offset:58176
    buffer_load_dwordx4 v[196:199], v12, s[60:63], s79 offen sc1
    s_add_u32 s79, s79, 2048
    v_mfma_f32_32x32x16_bf16 v[112:127], v[76:79], v[200:203], v[112:127]
    s_waitcnt lgkmcnt(0) vmcnt(11)
    v_mfma_f32_32x32x16_bf16 v[96:111], v[64:67], v[204:207], v[96:111]
    ds_read_b64_tr_b16 v[72:73], v52 offset:61248
    ds_read_b64_tr_b16 v[74:75], v52 offset:62272
    ds_read_b64_tr_b16 v[76:77], v53 offset:61248
    ds_read_b64_tr_b16 v[78:79], v53 offset:62272
    buffer_load_dwordx4 v[200:203], v12, s[60:63], s79 offen sc1
    s_add_u32 s79, s79, 2048
    v_mfma_f32_32x32x16_bf16 v[112:127], v[68:71], v[204:207], v[112:127]
    s_waitcnt lgkmcnt(0) vmcnt(11)
    v_mfma_f32_32x32x16_bf16 v[96:111], v[72:75], v[208:211], v[96:111]
    ds_read_b64_tr_b16 v[64:65], v52 offset:65344
    ds_read_b64_tr_b16 v[66:67], v54 offset:832
    ds_read_b64_tr_b16 v[68:69], v53 offset:65344
    ds_read_b64_tr_b16 v[70:71], v55 offset:832
    buffer_load_dwordx4 v[204:207], v12, s[60:63], s79 offen sc1
    s_add_u32 s79, s79, 2048
    v_mfma_f32_32x32x16_bf16 v[112:127], v[76:79], v[208:211], v[112:127]
    s_waitcnt lgkmcnt(0) vmcnt(11)
    v_mfma_f32_32x32x16_bf16 v[96:111], v[64:67], v[212:215], v[96:111]
    ds_read_b64_tr_b16 v[72:73], v54 offset:3904
    ds_read_b64_tr_b16 v[74:75], v54 offset:4928
    ds_read_b64_tr_b16 v[76:77], v55 offset:3904
    ds_read_b64_tr_b16 v[78:79], v55 offset:4928
    buffer_load_dwordx4 v[208:211], v12, s[60:63], s79 offen sc1
    s_add_u32 s79, s79, 2048
    v_mfma_f32_32x32x16_bf16 v[112:127], v[68:71], v[212:215], v[112:127]
    s_waitcnt lgkmcnt(0) vmcnt(11)
    v_mfma_f32_32x32x16_bf16 v[96:111], v[72:75], v[216:219], v[96:111]
    ds_read_b64_tr_b16 v[64:65], v54 offset:8000
    ds_read_b64_tr_b16 v[66:67], v54 offset:9024
    ds_read_b64_tr_b16 v[68:69], v55 offset:8000
    ds_read_b64_tr_b16 v[70:71], v55 offset:9024
    buffer_load_dwordx4 v[212:215], v12, s[60:63], s79 offen sc1
    s_add_u32 s79, s79, 2048
    v_mfma_f32_32x32x16_bf16 v[112:127], v[76:79], v[216:219], v[112:127]
    s_waitcnt lgkmcnt(0) vmcnt(11)
    v_mfma_f32_32x32x16_bf16 v[96:111], v[64:67], v[220:223], v[96:111]
    ds_read_b64_tr_b16 v[72:73], v54 offset:12096
    ds_read_b64_tr_b16 v[74:75], v54 offset:13120
    ds_read_b64_tr_b16 v[76:77], v55 offset:12096
    ds_read_b64_tr_b16 v[78:79], v55 offset:13120
    buffer_load_dwordx4 v[216:219], v12, s[60:63], s79 offen sc1
    s_add_u32 s79, s79, 2048
    v_mfma_f32_32x32x16_bf16 v[112:127], v[68:71], v[220:223], v[112:127]
    s_waitcnt lgkmcnt(0) vmcnt(11)
    v_mfma_f32_32x32x16_bf16 v[96:111], v[72:75], v[224:227], v[96:111]
    ds_read_b64_tr_b16 v[64:65], v54 offset:16192
    ds_read_b64_tr_b16 v[66:67], v54 offset:17216
    ds_read_b64_tr_b16 v[68:69], v55 offset:16192
    ds_read_b64_tr_b16 v[70:71], v55 offset:17216
    buffer_load_dwordx4 v[220:223], v12, s[60:63], s79 offen sc1
    s_add_u32 s79, s79, 2048
    v_mfma_f32_32x32x16_bf16 v[112:127], v[76:79], v[224:227], v[112:127]
    s_waitcnt lgkmcnt(0) vmcnt(11)
    v_mfma_f32_32x32x16_bf16 v[96:111], v[64:67], v[176:179], v[96:111]
    ds_read_b64_tr_b16 v[72:73], v54 offset:20288
    ds_read_b64_tr_b16 v[74:75], v54 offset:21312
    ds_read_b64_tr_b16 v[76:77], v55 offset:20288
    ds_read_b64_tr_b16 v[78:79], v55 offset:21312
    buffer_load_dwordx4 v[224:227], v12, s[60:63], s79 offen sc1
    s_add_u32 s79, s79, 2048
    v_mfma_f32_32x32x16_bf16 v[112:127], v[68:71], v[176:179], v[112:127]
    s_waitcnt lgkmcnt(0) vmcnt(11)
    v_mfma_f32_32x32x16_bf16 v[96:111], v[72:75], v[180:183], v[96:111]
    ds_read_b64_tr_b16 v[64:65], v54 offset:24384
    ds_read_b64_tr_b16 v[66:67], v54 offset:25408
    ds_read_b64_tr_b16 v[68:69], v55 offset:24384
    ds_read_b64_tr_b16 v[70:71], v55 offset:25408
    buffer_load_dwordx4 v[176:179], v12, s[60:63], s79 offen sc1
    s_add_u32 s79, s79, 2048
    v_mfma_f32_32x32x16_bf16 v[112:127], v[76:79], v[180:183], v[112:127]
    s_waitcnt lgkmcnt(0) vmcnt(11)
    v_mfma_f32_32x32x16_bf16 v[96:111], v[64:67], v[184:187], v[96:111]
    ds_read_b64_tr_b16 v[72:73], v54 offset:28480
    ds_read_b64_tr_b16 v[74:75], v54 offset:29504
    ds_read_b64_tr_b16 v[76:77], v55 offset:28480
    ds_read_b64_tr_b16 v[78:79], v55 offset:29504
    buffer_load_dwordx4 v[180:183], v12, s[60:63], s79 offen sc1
    s_add_u32 s79, s79, 2048
    v_mfma_f32_32x32x16_bf16 v[112:127], v[68:71], v[184:187], v[112:127]
    s_waitcnt lgkmcnt(0) vmcnt(11)
    v_mfma_f32_32x32x16_bf16 v[96:111], v[72:75], v[188:191], v[96:111]
    ds_read_b64_tr_b16 v[64:65], v50 offset:40768
    ds_read_b64_tr_b16 v[66:67], v50 offset:41792
    ds_read_b64_tr_b16 v[68:69], v51 offset:40768
    ds_read_b64_tr_b16 v[70:71], v51 offset:41792
    buffer_load_dwordx4 v[184:187], v12, s[60:63], s79 offen sc1
    s_add_u32 s79, s79, 2048
    v_mfma_f32_32x32x16_bf16 v[112:127], v[76:79], v[188:191], v[112:127]
    s_waitcnt lgkmcnt(0) vmcnt(11)
    v_mfma_f32_32x32x16_bf16 v[96:111], v[64:67], v[192:195], v[96:111]
    ds_read_b64_tr_b16 v[72:73], v50 offset:44864
    ds_read_b64_tr_b16 v[74:75], v50 offset:45888
    ds_read_b64_tr_b16 v[76:77], v51 offset:44864
    ds_read_b64_tr_b16 v[78:79], v51 offset:45888
    buffer_load_dwordx4 v[188:191], v12, s[60:63], s79 offen sc1
    s_add_u32 s79, s79, 2048
    v_mfma_f32_32x32x16_bf16 v[112:127], v[68:71], v[192:195], v[112:127]
    v_mov_b32 v14, s100
    v_mov_b32 v15, 1
    ds_write_b32 v14, v15 offset:21184
    s_waitcnt lgkmcnt(0) vmcnt(11)
    v_mfma_f32_32x32x16_bf16 v[96:111], v[72:75], v[196:199], v[96:111]
    ds_read_b64_tr_b16 v[64:65], v50 offset:48960
    ds_read_b64_tr_b16 v[66:67], v50 offset:49984
    ds_read_b64_tr_b16 v[68:69], v51 offset:48960
    ds_read_b64_tr_b16 v[70:71], v51 offset:49984
    v_mfma_f32_32x32x16_bf16 v[112:127], v[76:79], v[196:199], v[112:127]
    s_waitcnt lgkmcnt(0) vmcnt(10)
    v_mfma_f32_32x32x16_bf16 v[96:111], v[64:67], v[200:203], v[96:111]
    ds_read_b64_tr_b16 v[72:73], v50 offset:53056
    ds_read_b64_tr_b16 v[74:75], v50 offset:54080
    ds_read_b64_tr_b16 v[76:77], v51 offset:53056
    ds_read_b64_tr_b16 v[78:79], v51 offset:54080
    v_mfma_f32_32x32x16_bf16 v[112:127], v[68:71], v[200:203], v[112:127]
    s_waitcnt lgkmcnt(0) vmcnt(9)
    v_mfma_f32_32x32x16_bf16 v[96:111], v[72:75], v[204:207], v[96:111]
    ds_read_b64_tr_b16 v[64:65], v50 offset:57152
    ds_read_b64_tr_b16 v[66:67], v50 offset:58176
    ds_read_b64_tr_b16 v[68:69], v51 offset:57152
    ds_read_b64_tr_b16 v[70:71], v51 offset:58176
    v_mfma_f32_32x32x16_bf16 v[112:127], v[76:79], v[204:207], v[112:127]
    s_waitcnt lgkmcnt(0) vmcnt(8)
    v_mfma_f32_32x32x16_bf16 v[96:111], v[64:67], v[208:211], v[96:111]
    ds_read_b64_tr_b16 v[72:73], v50 offset:61248
    ds_read_b64_tr_b16 v[74:75], v50 offset:62272
    ds_read_b64_tr_b16 v[76:77], v51 offset:61248
    ds_read_b64_tr_b16 v[78:79], v51 offset:62272
    v_mfma_f32_32x32x16_bf16 v[112:127], v[68:71], v[208:211], v[112:127]
    s_waitcnt lgkmcnt(0) vmcnt(7)
    v_mfma_f32_32x32x16_bf16 v[96:111], v[72:75], v[212:215], v[96:111]
    ds_read_b64_tr_b16 v[64:65], v50 offset:65344
    ds_read_b64_tr_b16 v[66:67], v52 offset:832
    ds_read_b64_tr_b16 v[68:69], v51 offset:65344
    ds_read_b64_tr_b16 v[70:71], v53 offset:832
    v_mfma_f32_32x32x16_bf16 v[112:127], v[76:79], v[212:215], v[112:127]
    s_waitcnt lgkmcnt(0) vmcnt(6)
    v_mfma_f32_32x32x16_bf16 v[96:111], v[64:67], v[216:219], v[96:111]
    ds_read_b64_tr_b16 v[72:73], v52 offset:3904
    ds_read_b64_tr_b16 v[74:75], v52 offset:4928
    ds_read_b64_tr_b16 v[76:77], v53 offset:3904
    ds_read_b64_tr_b16 v[78:79], v53 offset:4928
    v_mfma_f32_32x32x16_bf16 v[112:127], v[68:71], v[216:219], v[112:127]
    s_waitcnt lgkmcnt(0) vmcnt(5)
    v_mfma_f32_32x32x16_bf16 v[96:111], v[72:75], v[220:223], v[96:111]
    ds_read_b64_tr_b16 v[64:65], v52 offset:8000
    ds_read_b64_tr_b16 v[66:67], v52 offset:9024
    ds_read_b64_tr_b16 v[68:69], v53 offset:8000
    ds_read_b64_tr_b16 v[70:71], v53 offset:9024
    v_mfma_f32_32x32x16_bf16 v[112:127], v[76:79], v[220:223], v[112:127]
    v_mov_b32 v14, 0
    s_mov_b32 s94, 0x400000
L_lw_13:
    ds_read_b128 v[32:35], v14 offset:21184
    s_waitcnt lgkmcnt(0)
    v_and_b32 v32, v32, v33
    v_and_b32 v34, v34, v35
    v_and_b32 v32, v32, v34
    s_nop 0
    v_readfirstlane_b32 s95, v32
    s_nop 0
    s_cmp_lg_u32 s95, 0
    s_cbranch_scc1 L_lwd_14
    s_sleep 1
    s_sub_u32 s94, s94, 1
    s_cbranch_scc0 L_lw_13
L_lwd_14:
    s_waitcnt lgkmcnt(0) vmcnt(4)
    v_mfma_f32_32x32x16_bf16 v[96:111], v[64:67], v[224:227], v[96:111]
    ds_read_b64_tr_b16 v[72:73], v52 offset:12096
    ds_read_b64_tr_b16 v[74:75], v52 offset:13120
    ds_read_b64_tr_b16 v[76:77], v53 offset:12096
    ds_read_b64_tr_b16 v[78:79], v53 offset:13120
    v_mfma_f32_32x32x16_bf16 v[112:127], v[68:71], v[224:227], v[112:127]
    s_waitcnt lgkmcnt(0) vmcnt(3)
    v_mfma_f32_32x32x16_bf16 v[96:111], v[72:75], v[176:179], v[96:111]
    ds_read_b64_tr_b16 v[64:65], v52 offset:16192
    ds_read_b64_tr_b16 v[66:67], v52 offset:17216
    ds_read_b64_tr_b16 v[68:69], v53 offset:16192
    ds_read_b64_tr_b16 v[70:71], v53 offset:17216
    v_mfma_f32_32x32x16_bf16 v[112:127], v[76:79], v[176:179], v[112:127]
    s_waitcnt lgkmcnt(0) vmcnt(2)
    v_mfma_f32_32x32x16_bf16 v[96:111], v[64:67], v[180:183], v[96:111]
    ds_read_b64_tr_b16 v[72:73], v52 offset:20288
    ds_read_b64_tr_b16 v[74:75], v52 offset:21312
    ds_read_b64_tr_b16 v[76:77], v53 offset:20288
    ds_read_b64_tr_b16 v[78:79], v53 offset:21312
    v_mfma_f32_32x32x16_bf16 v[112:127], v[68:71], v[180:183], v[112:127]
    s_waitcnt lgkmcnt(0) vmcnt(1)
    v_mfma_f32_32x32x16_bf16 v[96:111], v[72:75], v[184:187], v[96:111]
    ds_read_b64_tr_b16 v[64:65], v50 offset:16896
    ds_read_b64_tr_b16 v[66:67], v50 offset:17920
    ds_read_b64_tr_b16 v[68:69], v51 offset:16896
    ds_read_b64_tr_b16 v[70:71], v51 offset:17920
    v_mfma_f32_32x32x16_bf16 v[112:127], v[76:79], v[184:187], v[112:127]
    s_waitcnt lgkmcnt(0) vmcnt(0)
    v_mfma_f32_32x32x16_bf16 v[96:111], v[64:67], v[188:191], v[96:111]
    v_mfma_f32_32x32x16_bf16 v[112:127], v[68:71], v[188:191], v[112:127]
    s_nop 10
    ds_write_b128 v46, v[96:99] offset:0
    ds_write_b128 v46, v[100:103] offset:32
    ds_write_b128 v46, v[104:107] offset:64
    ds_write_b128 v46, v[108:111] offset:96
    ds_write_b128 v46, v[112:115] offset:128
    ds_write_b128 v46, v[116:119] offset:160
    ds_write_b128 v46, v[120:123] offset:192
    ds_write_b128 v46, v[124:127] offset:224
    s_waitcnt lgkmcnt(0)
    s_branch L_final
L_mask:
    v_mul_u32_u24 v210, 5462, v1
    v_mov_b32 v213, 0x7ff00000
    v_lshrrev_b32 v211, 16, v210
    v_mul_u32_u24 v211, 12, v211
    v_sub_u32 v211, v1, v211
    v_add_u32 v211, 0, v211
    v_cmp_lt_u32 vcc, 3, v211
    s_nop 1
    v_cndmask_b32 v4, v4, v213, vcc
    v_add_u32 v210, 349568, v210
    v_lshrrev_b32 v211, 16, v210
    v_mul_u32_u24 v211, 12, v211
    v_sub_u32 v211, v1, v211
    v_add_u32 v211, 64, v211
    v_cmp_lt_u32 vcc, 3, v211
    s_nop 1
    v_cndmask_b32 v5, v5, v213, vcc
    v_add_u32 v210, 349568, v210
    v_lshrrev_b32 v211, 16, v210
    v_mul_u32_u24 v211, 12, v211
    v_sub_u32 v211, v1, v211
    v_add_u32 v211, 128, v211
    v_cmp_lt_u32 vcc, 3, v211
    s_nop 1
    v_cndmask_b32 v6, v6, v213, vcc
    s_branch L_maskd
L_idle:
    v_lshrrev_b32 v14, 3, v1
    v_bfe_u32 v15, v1, 4, 1
    v_lshlrev_b32 v15, 2, v15
    v_and_b32 v13, 7, v1
    v_xor_b32 v13, v13, v15
    v_lshlrev_b32 v13, 4, v13
    v_lshl_add_u32 v13, v14, 10, v13
    v_bfe_u32 v14, v1, 2, 2
    v_lshrrev_b32 v15, 5, v1
    v_lshl_add_u32 v15, v15, 2, v14
    v_lshrrev_b32 v14, 1, v14
    v_lshlrev_b32 v14, 2, v14
    v_bfe_u32 v62, v1, 4, 1
    v_lshlrev_b32 v62, 1, v62
    v_bfe_u32 v63, v1, 1, 1
    v_add_u32 v62, v62, v63
    v_xor_b32 v62, v62, v14
    v_lshlrev_b32 v62, 4, v62
    v_lshl_add_u32 v62, v15, 7, v62
    v_and_b32 v63, 1, v1
    v_lshl_add_u32 v62, v63, 3, v62
    s_lshl_b32 s74, s89, 11
    v_add_u32 v50, s74, v62
    v_xor_b32 v51, 64, v50
    v_add_u32 v52, 65536, v50
    v_add_u32 v53, 65536, v51
    v_add_u32 v54, 131072, v50
    v_add_u32 v55, 131072, v51
    s_lshl_b32 s76, s70, 10
    s_lshl_b32 s77, s76, 3
    s_lshl_b32 s78, s92, 7
    s_add_u32 s77, s77, s78
    s_lshl1_add_u32 s74, s91, s88
    s_mul_i32 s74, s74, 86
    s_add_u32 s74, s74, s89
    s_lshl_b32 s83, s74, 10
    s_add_u32 s79, s83, 7340032
    v_and_b32 v46, 31, v1
    v_mul_u32_u24 v46, 272, v46
    v_lshrrev_b32 v47, 5, v1
    v_lshl_add_u32 v46, v47, 4, v46
    s_mul_i32 s74, s89, 17408
    s_mul_i32 s75, s88, 8704
    s_add_u32 s74, s74, s75
    s_add_u32 s74, s74, 89920
    v_add_u32 v46, s74, v46
    s_lshl1_add_u32 s81, s66, s88
    s_lshl4_add_u32 s81, s81, s67
    s_lshl1_add_u32 s81, s81, s89
    s_lshl_b32 s81, s81, 7
    s_add_u32 s81, s81, 327680
    v_mov_b32 v45, s69
    v_min_u32 v47, 28, v1
    v_lshlrev_b32 v47, 7, v47
    s_lshl_b32 s82, s91, 12
    s_add_u32 s82, s82, 327680
    s_waitcnt lgkmcnt(0)
    s_barrier
    s_barrier
    s_barrier
    s_barrier
    s_barrier
    s_barrier
    s_barrier
    s_barrier
    v_mov_b32 v14, s100
    v_mov_b32 v15, 1
    ds_write_b32 v14, v15 offset:21152
    s_branch L_gdone
L_opslow:
    v_mov_b32 v16, 0
    s_mov_b32 s94, 0x400000
L_lw_1:
    ds_read_b128 v[18:21], v16 offset:21200
    s_waitcnt lgkmcnt(0)
    v_and_b32 v18, v18, v19
    v_and_b32 v20, v20, v21
    v_and_b32 v18, v18, v20
    s_nop 0
    v_readfirstlane_b32 s95, v18
    s_nop 0
    s_cmp_lg_u32 s95, 0
    s_cbranch_scc1 L_lwd_2
    s_sleep 1
    s_sub_u32 s94, s94, 1
    s_cbranch_scc0 L_lw_1
L_lwd_2:
    ds_read_b128 v[36:39], v49 offset:0
    ds_read_b128 v[40:43], v49 offset:512
    ds_read_b64 v[160:161], v48 offset:16896
    ds_read_b64 v[164:165], v48 offset:17408
    ds_read_b64 v[168:169], v48 offset:17920
    s_waitcnt lgkmcnt(0)
    v_mov_b32 v172, v39
    v_and_b32 v173, 0xffff, v39
    v_mov_b32 v176, v43
    v_and_b32 v177, 0xffff, v43
    s_nop 1
    s_branch L_opok
L_B:
    v_lshrrev_b32 v210, 3, v1
    v_bfe_u32 v211, v1, 4, 1
    v_lshlrev_b32 v211, 2, v211
    v_and_b32 v7, 7, v1
    v_xor_b32 v7, v7, v211
    v_lshlrev_b32 v7, 4, v7
    v_lshl_add_u32 v7, v210, 10, v7
    v_lshlrev_b32 v210, 2, v1
    v_add_u32 v210, 21008, v210
    v_mov_b32 v211, 0
    ds_write_b32 v210, v211
    v_and_b32 v210, 1, v1
    v_mul_u32_u24 v210, 4640, v210
    v_bfe_u32 v212, v1, 1, 3
    v_sub_u32 v212, 7, v212
    v_lshl_add_u32 v210, v212, 6, v210
    v_lshrrev_b32 v212, 4, v1
    v_lshl_add_u32 v210, v212, 4, v210
    s_mul_i32 s74, s88, 9280
    s_add_u32 s74, s74, 22208
    s_lshl_b32 s75, s89, 8
    s_add_u32 s74, s74, s75
    v_add_u32 v8, s74, v210
    v_bfe_u32 v210, v1, 2, 2
    v_add_u32 v210, v210, v212
    v_lshlrev_b32 v210, 4, v210
    v_and_b32 v213, 3, v1
    v_lshl_add_u32 v210, v213, 2, v210
    v_and_b32 v213, 1, v1
    v_mul_u32_u24 v213, 4220, v213
    v_sub_u32 v210, v210, v213
    s_mul_i32 s74, s88, 8448
    s_add_u32 s74, s74, 4224
    s_add_u32 s74, s74, s75
    v_add_u32 v9, s74, v210
    v_bfe_u32 v210, v1, 2, 2
    v_mul_u32_u24 v210, 1088, v210
    v_lshrrev_b32 v211, 4, v1
    v_lshl_add_u32 v210, v211, 5, v210
    v_and_b32 v211, 3, v1
    v_lshl_add_u32 v210, v211, 3, v210
    s_lshl_b32 s74, s70, 8
    s_add_u32 s74, s74, 12304
    v_add_u32 v10, s74, v210
    s_mul_i32 s74, s88, 6144
    s_add_u32 s74, s74, 16
    v_lshl_add_u32 v84, v1, 3, s74
    v_add_u32 v85, s74, v12
    v_add_u32 v86, -4, v85
    s_mul_i32 s74, s70, 4640
    s_add_u32 s74, s74, 22208
    v_sub_u32 v213, 63, v1
    v_lshl_add_u32 v87, v213, 5, s74
    v_lshl_add_u32 v88, v213, 4, s74
    v_lshl_add_u32 v89, v213, 3, s74
    s_cmp_eq_u32 s89, 1
    s_cselect_b64 s[72:73], -1, 0
    v_bfe_u32 v210, v1, 4, 1
    v_mul_u32_u24 v210, 12320, v210
    v_bfe_u32 v211, v1, 2, 2
    v_lshrrev_b32 v212, 5, v1
    v_lshl_add_u32 v211, v212, 3, v211
    v_mul_u32_u24 v211, 192, v211
    v_and_b32 v212, 3, v1
    v_lshlrev_b32 v212, 3, v212
    v_add3_u32 v210, v210, v211, v212
    s_bfe_u32 s74, s66, 0x10002
    s_mul_i32 s74, s74, 0
    v_add_u32 v210, s74, v210
    s_lshl_b32 s74, s70, 5
    s_add_u32 s74, s74, 98176
    v_add_u32 v93, s74, v210
    s_lshl_b32 s74, s89, 5
    s_add_u32 s74, s74, 98304
    v_add_u32 v94, s74, v210
    v_mov_b32 v96, 0x3f803f80
    v_mov_b32 v97, 0x3f803f80
    v_mov_b32 v98, 0x3f803f80
    v_mov_b32 v99, 0x3f803f80
    s_lshr_b32 s74, s66, 3
    s_lshl4_add_u32 s74, s74, s67
    s_lshl2_add_u32 s74, s74, s70
    s_lshl_b32 s12, s74, 12
    s_add_u32 s12, s12, 13631488
    v_and_b32 v95, 0x1ff, v12
    s_waitcnt lgkmcnt(0) vmcnt(5)
    s_lshl_b32 s74, s88, 4
    s_lshr_b32 s14, s14, s74
    v_mov_b32 v28, s14
    v_lshlrev_b32 v160, 16, v16
    s_lshl_b32 s78, s86, 7
    s_add_u32 s78, s78, s84
    s_mul_i32 s79, s86, 176128
    s_add_u32 s79, s79, s85
    s_add_u32 s86, s86, 1
    s_and_b32 s86, s86, 7
    v_and_b32 v161, 0xffff0000, v16
    v_lshlrev_b32 v162, 16, v17
    v_and_b32 v163, 0xffff0000, v17
    v_lshlrev_b32 v164, 16, v18
    v_and_b32 v165, 0xffff0000, v18
    v_lshlrev_b32 v166, 16, v19
    v_and_b32 v167, 0xffff0000, v19
    v_lshlrev_b32 v168, 16, v20
    v_and_b32 v169, 0xffff0000, v20
    v_lshlrev_b32 v170, 16, v21
    v_and_b32 v171, 0xffff0000, v21
    v_lshlrev_b32 v172, 16, v22
    v_and_b32 v173, 0xffff0000, v22
    v_lshlrev_b32 v174, 16, v23
    v_and_b32 v175, 0xffff0000, v23
    v_readfirstlane_b32 s4, v160
    v_readfirstlane_b32 s6, v168
    s_nop 0
    v_pk_add_f32 v[176:177], v[160:161], s[4:5] op_sel_hi:[1,0] neg_lo:[0,1] neg_hi:[0,1]
    s_add_u32 m0, s80, 122816
    s_nop 0
    buffer_load_dwordx4 v2, s[44:47], s78 offen offset:0 lds
    v_pk_add_f32 v[184:185], v[168:169], s[6:7] op_sel_hi:[1,0] neg_lo:[0,1] neg_hi:[0,1]
    v_pk_add_f32 v[178:179], v[162:163], s[4:5] op_sel_hi:[1,0] neg_lo:[0,1] neg_hi:[0,1]
    v_pk_add_f32 v[186:187], v[170:171], s[6:7] op_sel_hi:[1,0] neg_lo:[0,1] neg_hi:[0,1]
    v_pk_add_f32 v[180:181], v[164:165], s[4:5] op_sel_hi:[1,0] neg_lo:[0,1] neg_hi:[0,1]
    v_pk_add_f32 v[188:189], v[172:173], s[6:7] op_sel_hi:[1,0] neg_lo:[0,1] neg_hi:[0,1]
    v_pk_add_f32 v[182:183], v[166:167], s[4:5] op_sel_hi:[1,0] neg_lo:[0,1] neg_hi:[0,1]
    v_pk_add_f32 v[190:191], v[174:175], s[6:7] op_sel_hi:[1,0] neg_lo:[0,1] neg_hi:[0,1]
    v_pk_add_f32 v[192:193], v[176:177], v[178:179]
    v_pk_add_f32 v[194:195], v[180:181], v[182:183]
    v_pk_mul_f32 v[196:197], v[176:177], v[176:177]
    v_pk_add_f32 v[198:199], v[184:185], v[186:187]
    v_pk_add_f32 v[200:201], v[188:189], v[190:191]
    v_pk_mul_f32 v[202:203], v[184:185], v[184:185]
    v_pk_fma_f32 v[196:197], v[178:179], v[178:179], v[196:197]
    v_pk_add_f32 v[192:193], v[192:193], v[194:195]
    v_pk_fma_f32 v[202:203], v[186:187], v[186:187], v[202:203]
    v_pk_add_f32 v[198:199], v[198:199], v[200:201]
    v_pk_fma_f32 v[196:197], v[180:181], v[180:181], v[196:197]
    s_add_u32 s78, s78, 7168
    buffer_load_dwordx4 v3, s[44:47], s78 offen offset:1024 lds
    v_pk_fma_f32 v[202:203], v[188:189], v[188:189], v[202:203]
    v_pk_fma_f32 v[196:197], v[182:183], v[182:183], v[196:197]
    v_pk_fma_f32 v[202:203], v[190:191], v[190:191], v[202:203]
    v_add_f32 v192, v192, v193
    v_add_f32 v196, v196, v197
    v_add_f32 v198, v198, v199
    v_add_f32 v202, v202, v203
    v_add_f32_dpp v192, v192, v192 row_shr:1 row_mask:0xf bank_mask:0xf
    v_add_f32_dpp v198, v198, v198 row_shr:1 row_mask:0xf bank_mask:0xf
    v_add_f32_dpp v196, v196, v196 row_shr:1 row_mask:0xf bank_mask:0xf
    v_add_f32_dpp v202, v202, v202 row_shr:1 row_mask:0xf bank_mask:0xf
    v_add_f32_dpp v192, v192, v192 row_shr:2 row_mask:0xf bank_mask:0xf
    v_add_f32_dpp v198, v198, v198 row_shr:2 row_mask:0xf bank_mask:0xf
    v_add_f32_dpp v196, v196, v196 row_shr:2 row_mask:0xf bank_mask:0xf
    v_add_f32_dpp v202, v202, v202 row_shr:2 row_mask:0xf bank_mask:0xf
    v_add_f32_dpp v192, v192, v192 row_shr:4 row_mask:0xf bank_mask:0xf
    v_add_f32_dpp v198, v198, v198 row_shr:4 row_mask:0xf bank_mask:0xf
    v_add_f32_dpp v196, v196, v196 row_shr:4 row_mask:0xf bank_mask:0xf
    s_add_u32 s78, s78, 7168
    buffer_load_dwordx4 v2, s[44:47], s78 offen offset:2048 lds
    v_add_f32_dpp v202, v202, v202 row_shr:4 row_mask:0xf bank_mask:0xf
    v_add_f32_dpp v192, v192, v192 row_shr:8 row_mask:0xf bank_mask:0xf
    v_add_f32_dpp v198, v198, v198 row_shr:8 row_mask:0xf bank_mask:0xf
    v_add_f32_dpp v196, v196, v196 row_shr:8 row_mask:0xf bank_mask:0xf
    v_add_f32_dpp v202, v202, v202 row_shr:8 row_mask:0xf bank_mask:0xf
    v_add_f32_dpp v192, v192, v192 row_bcast:15 row_mask:0xa bank_mask:0xf
    v_add_f32_dpp v198, v198, v198 row_bcast:15 row_mask:0xa bank_mask:0xf
    v_add_f32_dpp v196, v196, v196 row_bcast:15 row_mask:0xa bank_mask:0xf
    v_add_f32_dpp v202, v202, v202 row_bcast:15 row_mask:0xa bank_mask:0xf
    v_add_f32_dpp v192, v192, v192 row_bcast:31 row_mask:0xc bank_mask:0xf
    v_add_f32_dpp v198, v198, v198 row_bcast:31 row_mask:0xc bank_mask:0xf
    v_add_f32_dpp v196, v196, v196 row_bcast:31 row_mask:0xc bank_mask:0xf
    v_add_f32_dpp v202, v202, v202 row_bcast:31 row_mask:0xc bank_mask:0xf
    v_readlane_b32 s8, v192, 63
    v_readlane_b32 s9, v198, 63
    v_readlane_b32 s10, v196, 63
    v_readlane_b32 s11, v202, 63
    v_mov_b32 v204, 0x3b000000
    v_mul_f32 v192, s8, v204
    s_add_u32 s78, s78, 7168
    buffer_load_dwordx4 v3, s[44:47], s78 offen offset:3072 lds
    v_mul_f32 v193, s9, v204
    v_mul_f32 v194, s10, v204
    v_mul_f32 v195, s11, v204
    v_fma_f32 v194, -v192, v192, v194
    v_fma_f32 v195, -v193, v193, v195
    v_add_f32 v192, s4, v192
    v_add_f32 v193, s6, v193
    v_max_f32 v194, 0, v194
    v_max_f32 v195, 0, v195
    v_cvt_pk_bf16_f32 v196, v192, v193
    v_cvt_pk_bf16_f32 v194, v194, v195
    v_lshlrev_b32 v198, 16, v196
    v_and_b32 v200, 0xffff0000, v196
    v_lshlrev_b32 v202, 16, v194
    v_and_b32 v203, 0xffff0000, v194
    v_add_f32 v202, 0x3727c5ac, v202
    v_add_f32 v203, 0x3727c5ac, v203
    v_cvt_pk_bf16_f32 v194, v202, v203
    s_add_u32 m0, s81, 139200
    s_nop 0
    buffer_load_dwordx4 v4, s[48:51], s79 offen offset:0 lds
    v_pk_add_f32 v[160:161], v[160:161], v[198:199] op_sel_hi:[1,0] neg_lo:[0,1] neg_hi:[0,1]
    v_pk_add_f32 v[162:163], v[162:163], v[198:199] op_sel_hi:[1,0] neg_lo:[0,1] neg_hi:[0,1]
    v_lshlrev_b32 v202, 16, v194
    v_and_b32 v203, 0xffff0000, v194
    v_pk_add_f32 v[164:165], v[164:165], v[198:199] op_sel_hi:[1,0] neg_lo:[0,1] neg_hi:[0,1]
    v_pk_add_f32 v[166:167], v[166:167], v[198:199] op_sel_hi:[1,0] neg_lo:[0,1] neg_hi:[0,1]
    v_sqrt_f32 v202, v202
    v_sqrt_f32 v203, v203
    v_pk_add_f32 v[168:169], v[168:169], v[200:201] op_sel_hi:[1,0] neg_lo:[0,1] neg_hi:[0,1]
    v_pk_add_f32 v[170:171], v[170:171], v[200:201] op_sel_hi:[1,0] neg_lo:[0,1] neg_hi:[0,1]
    v_cvt_pk_bf16_f32 v194, v202, v203
    v_pk_add_f32 v[172:173], v[172:173], v[200:201] op_sel_hi:[1,0] neg_lo:[0,1] neg_hi:[0,1]
    v_pk_add_f32 v[174:175], v[174:175], v[200:201] op_sel_hi:[1,0] neg_lo:[0,1] neg_hi:[0,1]
    v_lshlrev_b32 v202, 16, v194
    v_and_b32 v203, 0xffff0000, v194
    v_rcp_f32 v176, v202
    v_rcp_f32 v178, v203
    v_pk_mul_f32 v[160:161], v[160:161], v[176:177] op_sel_hi:[1,0]
    buffer_load_dwordx4 v5, s[48:51], s79 offen offset:1024 lds
    v_pk_mul_f32 v[162:163], v[162:163], v[176:177] op_sel_hi:[1,0]
    v_pk_mul_f32 v[164:165], v[164:165], v[176:177] op_sel_hi:[1,0]
    v_pk_mul_f32 v[166:167], v[166:167], v[176:177] op_sel_hi:[1,0]
    v_pk_mul_f32 v[168:169], v[168:169], v[178:179] op_sel_hi:[1,0]
    v_pk_mul_f32 v[170:171], v[170:171], v[178:179] op_sel_hi:[1,0]
    v_pk_mul_f32 v[172:173], v[172:173], v[178:179] op_sel_hi:[1,0]
    v_pk_mul_f32 v[174:175], v[174:175], v[178:179] op_sel_hi:[1,0]
    v_cvt_pk_bf16_f32 v16, v160, v161
    v_cvt_pk_bf16_f32 v17, v162, v163
    v_cvt_pk_bf16_f32 v18, v164, v165
    v_cvt_pk_bf16_f32 v19, v166, v167
    v_cvt_pk_bf16_f32 v20, v168, v169
    v_cvt_pk_bf16_f32 v21, v170, v171
    v_cvt_pk_bf16_f32 v22, v172, v173
    v_cvt_pk_bf16_f32 v23, v174, v175
    s_mul_i32 s4, s70, 2176
    s_add_u32 s4, s4, 12304
    v_add_u32 v204, s4, v12
    buffer_load_dwordx4 v6, s[48:51], s79 offen offset:2048 lds
    ds_write_b128 v204, v[16:19]
    ds_write_b128 v204, v[20:23] offset:1088
    v_readfirstlane_b32 s69, v29
    s_nop 0
    s_mul_i32 s69, s69, 0x9E3779B1
    s_add_u32 s69, s69, 0x7F4A7C15
    v_xor_b32 v196, 0x80008000, v196
    v_and_b32 v192, 0xffff, v196
    v_or_b32 v192, v192, v202
    v_lshrrev_b32 v193, 16, v196
    v_or_b32 v193, v193, v203
    v_cmp_eq_u32 vcc, 0, v1
    v_lshlrev_b32 v194, 3, v1
    s_nop 0
    v_cndmask_b32 v192, v193, v192, vcc
    v_mov_b32 v193, s69
    s_lshl_b32 s4, s71, 6
    s_lshl_b32 s5, s70, 4
    s_add_u32 s4, s4, s5
    s_add_u32 s4, s4, 8192
    s_mov_b64 exec, 3
    buffer_store_dwordx2 v[192:193], v194, s[60:63], s4 offen sc1
    s_mov_b64 exec, -1
    s_waitcnt lgkmcnt(0) vmcnt(8)
    s_barrier
    ds_read_b64_tr_b16 v[20:21], v10 offset:0
    ds_read_b64_tr_b16 v[22:23], v10 offset:4352
    ds_read_b64_tr_b16 v[24:25], v10 offset:128
    ds_read_b64_tr_b16 v[26:27], v10 offset:4480
    s_add_u32 m0, s81, 151520
    s_nop 0
    buffer_load_dwordx4 v4, s[52:55], s79 offen offset:0 lds
    buffer_load_dwordx4 v5, s[52:55], s79 offen offset:1024 lds
    buffer_load_dwordx4 v6, s[52:55], s79 offen offset:2048 lds
    s_lshl_b32 s78, s86, 7
    ds_read_b64_tr_b16 v[100:101], v93 offset:0
    s_add_u32 s78, s78, s84
    ds_read_b64_tr_b16 v[116:117], v94 offset:0
    s_mul_i32 s79, s86, 176128
    ds_read_b64_tr_b16 v[102:103], v93 offset:768
    s_add_u32 s79, s79, s85
    ds_read_b64_tr_b16 v[118:119], v94 offset:768
    s_add_u32 s86, s86, 1
    ds_read_b64_tr_b16 v[104:105], v93 offset:3072
    s_and_b32 s86, s86, 7
    ds_read_b64_tr_b16 v[120:121], v94 offset:3072
    s_add_u32 m0, s80, 40768
    s_nop 0
    buffer_load_dwordx4 v2, s[44:47], s78 offen offset:0 lds
    ds_read_b64_tr_b16 v[106:107], v93 offset:3840
    s_add_u32 s78, s78, 7168
    buffer_load_dwordx4 v3, s[44:47], s78 offen offset:1024 lds
    ds_read_b64_tr_b16 v[122:123], v94 offset:3840
    s_add_u32 s78, s78, 7168
    buffer_load_dwordx4 v2, s[44:47], s78 offen offset:2048 lds
    ds_read_b64_tr_b16 v[108:109], v93 offset:6144
    s_add_u32 s78, s78, 7168
    buffer_load_dwordx4 v3, s[44:47], s78 offen offset:3072 lds
    ds_read_b64_tr_b16 v[124:125], v94 offset:6144
    s_add_u32 m0, s81, 57152
    s_nop 0
    buffer_load_dwordx4 v4, s[48:51], s79 offen offset:0 lds
    ds_read_b64_tr_b16 v[110:111], v93 offset:6912
    buffer_load_dwordx4 v5, s[48:51], s79 offen offset:1024 lds
    ds_read_b64_tr_b16 v[126:127], v94 offset:6912
    buffer_load_dwordx4 v6, s[48:51], s79 offen offset:2048 lds
    ds_read_b64_tr_b16 v[112:113], v93 offset:9216
    s_add_u32 m0, s81, 69472
    s_nop 0
    buffer_load_dwordx4 v4, s[52:55], s79 offen offset:0 lds
    ds_read_b64_tr_b16 v[128:129], v94 offset:9216
    buffer_load_dwordx4 v5, s[52:55], s79 offen offset:1024 lds
    ds_read_b64_tr_b16 v[114:115], v93 offset:9984
    buffer_load_dwordx4 v6, s[52:55], s79 offen offset:2048 lds
    ds_read_b64_tr_b16 v[130:131], v94 offset:9984
    s_lshl_b32 s74, s71, 13
    s_lshl_b32 s75, s70, 11
    s_add_u32 s74, s74, s75
    s_add_u32 s74, s74, 1048576
    s_waitcnt lgkmcnt(0)
    buffer_store_dwordx4 v[20:23], v12, s[60:63], s74 offen offset:0 sc1
    buffer_store_dwordx4 v[24:27], v12, s[60:63], s74 offen offset:1024 sc1
    s_waitcnt vmcnt(12)
    s_barrier
    s_setprio 2
    s_lshl_b32 s78, s86, 7
    v_mfma_f32_32x32x16_bf16 v[132:147], v[96:99], v[100:103], 0
    v_mfma_f32_32x32x16_bf16 v[148:163], v[96:99], v[116:119], 0
    s_add_u32 s78, s78, s84
    v_mfma_f32_32x32x16_bf16 v[132:147], v[96:99], v[104:107], v[132:147]
    s_mul_i32 s79, s86, 176128
    v_mfma_f32_32x32x16_bf16 v[148:163], v[96:99], v[120:123], v[148:163]
    ds_read_b64 v[32:33], v84 offset:2048
    s_add_u32 s79, s79, s85
    ds_read_b32 v34, v84 offset:2056
    s_add_u32 s86, s86, 1
    ds_read_b32 v35, v84 offset:1020
    s_and_b32 s86, s86, 7
    ds_read_b64 v[36:37], v84 offset:1536
    ds_read_b32 v38, v84 offset:1544
    s_add_u32 m0, s80, 81792
    s_nop 0
    buffer_load_dwordx4 v2, s[44:47], s78 offen offset:0 lds
    ds_read_b32 v39, v86 offset:0
    s_add_u32 s78, s78, 7168
    buffer_load_dwordx4 v3, s[44:47], s78 offen offset:1024 lds
    ds_read_b64 v[40:41], v84 offset:1024
    s_add_u32 s78, s78, 7168
    buffer_load_dwordx4 v2, s[44:47], s78 offen offset:2048 lds
    ds_read_b32 v42, v84 offset:1032
    ds_read_b128 v[44:47], v85 offset:0
    s_add_u32 s78, s78, 7168
    buffer_load_dwordx4 v3, s[44:47], s78 offen offset:3072 lds
    ds_read_b64 v[48:49], v84 offset:5120
    s_add_u32 m0, s81, 98176
    s_nop 0
    buffer_load_dwordx4 v4, s[48:51], s79 offen offset:0 lds
    ds_read_b32 v50, v84 offset:5128
    ds_read_b32 v51, v84 offset:4092
    buffer_load_dwordx4 v5, s[48:51], s79 offen offset:1024 lds
    ds_read_b64 v[52:53], v84 offset:4608
    buffer_load_dwordx4 v6, s[48:51], s79 offen offset:2048 lds
    ds_read_b32 v54, v84 offset:4616
    s_add_u32 m0, s81, 110496
    s_nop 0
    buffer_load_dwordx4 v4, s[52:55], s79 offen offset:0 lds
    ds_read_b32 v55, v86 offset:3072
    ds_read_b64 v[56:57], v84 offset:4096
    buffer_load_dwordx4 v5, s[52:55], s79 offen offset:1024 lds
    ds_read_b32 v58, v84 offset:4104
    buffer_load_dwordx4 v6, s[52:55], s79 offen offset:2048 lds
    ds_read_b128 v[60:63], v85 offset:3072
    s_waitcnt lgkmcnt(0) vmcnt(12)
    s_barrier
    s_lshl_b32 s78, s86, 7
    v_mfma_f32_32x32x16_bf16 v[132:147], v[96:99], v[108:111], v[132:147]
    v_mfma_f32_32x32x16_bf16 v[148:163], v[96:99], v[124:127], v[148:163]
    v_mfma_f32_32x32x16_bf16 v[132:147], v[96:99], v[112:115], v[132:147]
    s_add_u32 s78, s78, s84
    v_mfma_f32_32x32x16_bf16 v[148:163], v[96:99], v[128:131], v[148:163]
    v_cmp_eq_u32 vcc, 0, v1
    s_mul_i32 s79, s86, 176128
    v_lshlrev_b32 v28, 16, v28
    v_add_f32 v32, v32, v48
    s_add_u32 s79, s79, s85
    v_add_f32 v33, v33, v49
    v_add_f32 v34, v34, v50
    s_add_u32 s86, s86, 1
    v_add_f32 v35, v35, v51
    v_add_f32 v36, v36, v52
    s_and_b32 s86, s86, 7
    v_add_f32 v37, v37, v53
    v_add_f32 v38, v38, v54
    v_add_f32 v39, v39, v55
    s_add_u32 m0, s80, 122816
    s_nop 0
    buffer_load_dwordx4 v2, s[44:47], s78 offen offset:0 lds
    v_add_f32 v40, v40, v56
    v_add_f32 v41, v41, v57
    s_add_u32 s78, s78, 7168
    buffer_load_dwordx4 v3, s[44:47], s78 offen offset:1024 lds
    v_add_f32 v42, v42, v58
    v_add_f32 v44, v44, v60
    s_add_u32 s78, s78, 7168
    buffer_load_dwordx4 v2, s[44:47], s78 offen offset:2048 lds
    v_add_f32 v45, v45, v61
    v_add_f32 v46, v46, v62
    s_add_u32 s78, s78, 7168
    buffer_load_dwordx4 v3, s[44:47], s78 offen offset:3072 lds
    v_add_f32 v47, v47, v63
    v_cndmask_b32 v28, 0, v28, vcc
    s_add_u32 m0, s81, 139200
    s_nop 0
    buffer_load_dwordx4 v4, s[48:51], s79 offen offset:0 lds
    v_cndmask_b32 v35, v40, v35, vcc
    v_cndmask_b32 v39, v39, 0, vcc
    v_add_f32 v44, v44, v28
    buffer_load_dwordx4 v5, s[48:51], s79 offen offset:1024 lds
    v_cndmask_b32 v48, v33, v34, s[72:73]
    v_cndmask_b32 v49, v32, v33, s[72:73]
    buffer_load_dwordx4 v6, s[48:51], s79 offen offset:2048 lds
    v_cvt_pk_bf16_f32 v64, v34, v34
    v_cvt_pk_bf16_f32 v65, v34, v48
    s_add_u32 m0, s81, 151520
    s_nop 0
    buffer_load_dwordx4 v4, s[52:55], s79 offen offset:0 lds
    v_cvt_pk_bf16_f32 v66, v33, v33
    v_cvt_pk_bf16_f32 v67, v33, v33
    buffer_load_dwordx4 v5, s[52:55], s79 offen offset:1024 lds
    v_cvt_pk_bf16_f32 v68, v33, v33
    v_cvt_pk_bf16_f32 v69, v49, v32
    buffer_load_dwordx4 v6, s[52:55], s79 offen offset:2048 lds
    v_cvt_pk_bf16_f32 v70, v32, v32
    v_cvt_pk_bf16_f32 v71, v32, v32
    s_setprio 0
    v_mov_b32 v133, v148
    v_mov_b32 v134, s69
    s_and_b32 s74, s66, 7
    s_lshl_b32 s74, s74, 9
    s_add_u32 s74, s74, s12
    buffer_store_dwordx4 v[132:135], v95, s[60:63], s74 offen sc1
    s_waitcnt vmcnt(11)
    s_barrier
    s_lshl_b32 s74, s71, 2
    s_add_u32 s74, s74, 4096
    s_cmp_eq_u32 s70, 0
    s_cselect_b32 s74, s74, 0x7ffffff0
    v_mov_b32 v16, s69
    buffer_store_dword v16, off, s[60:63], s74 sc1
    s_lshl_b32 s78, s86, 7
    v_cndmask_b32 v48, v37, v38, s[72:73]
    v_cndmask_b32 v49, v36, v37, s[72:73]
    s_add_u32 s78, s78, s84
    v_cvt_pk_bf16_f32 v72, v38, v48
    s_mul_i32 s79, s86, 176128
    v_cvt_pk_bf16_f32 v73, v37, v37
    s_add_u32 s79, s79, s85
    v_cvt_pk_bf16_f32 v74, v49, v36
    s_add_u32 s86, s86, 1
    v_cvt_pk_bf16_f32 v75, v36, v36
    s_and_b32 s86, s86, 7
    v_cndmask_b32 v48, v41, v42, s[72:73]
    v_cndmask_b32 v49, v40, v41, s[72:73]
    s_add_u32 m0, s80, 40768
    s_nop 0
    buffer_load_dwordx4 v2, s[44:47], s78 offen offset:0 lds
    v_cndmask_b32 v50, v35, v40, s[72:73]
    s_add_u32 s78, s78, 7168
    buffer_load_dwordx4 v3, s[44:47], s78 offen offset:1024 lds
    v_cvt_pk_bf16_f32 v76, v48, v49
    s_add_u32 s78, s78, 7168
    buffer_load_dwordx4 v2, s[44:47], s78 offen offset:2048 lds
    v_cvt_pk_bf16_f32 v77, v40, v50
    s_add_u32 s78, s78, 7168
    buffer_load_dwordx4 v3, s[44:47], s78 offen offset:3072 lds
    v_cndmask_b32 v48, v46, v47, s[72:73]
    s_add_u32 m0, s81, 57152
    s_nop 0
    buffer_load_dwordx4 v4, s[48:51], s79 offen offset:0 lds
    v_cndmask_b32 v49, v45, v46, s[72:73]
    v_cndmask_b32 v50, v44, v45, s[72:73]
    buffer_load_dwordx4 v5, s[48:51], s79 offen offset:1024 lds
    v_cndmask_b32 v51, v39, v44, s[72:73]
    buffer_load_dwordx4 v6, s[48:51], s79 offen offset:2048 lds
    v_cvt_pk_bf16_f32 v78, v48, v49
    s_add_u32 m0, s81, 69472
    s_nop 0
    buffer_load_dwordx4 v4, s[52:55], s79 offen offset:0 lds
    v_cvt_pk_bf16_f32 v79, v50, v51
    buffer_load_dwordx4 v5, s[52:55], s79 offen offset:1024 lds
    v_mov_b32 v80, 0
    buffer_load_dwordx4 v6, s[52:55], s79 offen offset:2048 lds
    v_mov_b32 v81, 0
    s_waitcnt vmcnt(12)
    s_barrier
    s_lshl_b32 s78, s86, 7
    v_lshrrev_b32 v16, 1, v1
    s_add_u32 s78, s78, s84
    v_and_b32 v17, 1, v1
    s_mul_i32 s79, s86, 176128
    v_lshlrev_b32 v90, 13, v16
    s_add_u32 s79, s79, s85
    v_lshl_add_u32 v90, v17, 4, v90
    s_add_u32 s86, s86, 1
    v_mul_u32_u24 v17, 8448, v17
    s_and_b32 s86, s86, 7
    v_lshl_add_u32 v17, v16, 4, v17
    s_add_u32 m0, s80, 81792
    s_nop 0
    buffer_load_dwordx4 v2, s[44:47], s78 offen offset:0 lds
    s_lshl_b32 s74, s70, 10
    s_add_u32 s78, s78, 7168
    buffer_load_dwordx4 v3, s[44:47], s78 offen offset:1024 lds
    s_add_u32 s78, s78, 7168
    buffer_load_dwordx4 v2, s[44:47], s78 offen offset:2048 lds
    s_add_u32 s74, s74, 0
    s_add_u32 s78, s78, 7168
    buffer_load_dwordx4 v3, s[44:47], s78 offen offset:3072 lds
    v_add_u32 v91, s74, v17
    s_add_u32 m0, s81, 98176
    s_nop 0
    buffer_load_dwordx4 v4, s[48:51], s79 offen offset:0 lds
    s_mul_i32 s74, s70, 4224
    buffer_load_dwordx4 v5, s[48:51], s79 offen offset:1024 lds
    s_add_u32 s74, s74, 0
    buffer_load_dwordx4 v6, s[48:51], s79 offen offset:2048 lds
    s_sub_u32 s75, 15, s89
    s_add_u32 m0, s81, 110496
    s_nop 0
    buffer_load_dwordx4 v4, s[52:55], s79 offen offset:0 lds
    v_min_u32 v92, s75, v1
    buffer_load_dwordx4 v5, s[52:55], s79 offen offset:1024 lds
    v_lshl_add_u32 v92, v92, 2, s74
    buffer_load_dwordx4 v6, s[52:55], s79 offen offset:2048 lds
    s_waitcnt vmcnt(10)
    s_barrier
    v_lshrrev_b32 v17, 5, v1
    v_lshl_add_u32 v94, v17, 11, v95
    v_lshrrev_b32 v93, 1, v95
    s_lshl2_add_u32 s13, s66, s70
    s_lshl_b32 s13, s13, 8
    s_add_u32 s13, s13, 8192
    buffer_load_dwordx2 v[100:101], v93, s[60:63], s13 offen sc1
    buffer_load_dwordx4 v[104:107], v94, s[60:63], s12 offen offset:0 sc1
    buffer_load_dwordx4 v[108:111], v94, s[60:63], s12 offen offset:512 sc1
    buffer_load_dwordx4 v[112:115], v94, s[60:63], s12 offen offset:1024 sc1
    buffer_load_dwordx4 v[116:119], v94, s[60:63], s12 offen offset:1536 sc1
    s_lshl_b32 s78, s86, 7
    v_mov_b32 v32, 0
    v_mov_b32 v33, 0
    s_add_u32 s78, s78, s84
    v_mov_b32 v34, 0
    v_mov_b32 v35, 0
    s_mul_i32 s79, s86, 176128
    v_mov_b32 v36, 0
    v_mov_b32 v37, 0
    s_add_u32 s79, s79, s85
    v_mov_b32 v38, 0
    v_mov_b32 v39, 0
    s_add_u32 s86, s86, 1
    v_mov_b32 v40, 0
    v_mov_b32 v41, 0
    s_and_b32 s86, s86, 7
    v_mov_b32 v42, 0
    v_mov_b32 v43, 0
    s_add_u32 m0, s80, 122816
    s_nop 0
    buffer_load_dwordx4 v2, s[44:47], s78 offen offset:0 lds
    v_mov_b32 v44, 0
    v_mov_b32 v45, 0
    s_add_u32 s78, s78, 7168
    buffer_load_dwordx4 v3, s[44:47], s78 offen offset:1024 lds
    v_mov_b32 v46, 0
    v_mov_b32 v47, 0
    s_add_u32 s78, s78, 7168
    buffer_load_dwordx4 v2, s[44:47], s78 offen offset:2048 lds
    v_mov_b32 v48, 0
    v_mov_b32 v49, 0
    s_add_u32 s78, s78, 7168
    buffer_load_dwordx4 v3, s[44:47], s78 offen offset:3072 lds
    v_mov_b32 v50, 0
    v_mov_b32 v51, 0
    s_add_u32 m0, s81, 139200
    s_nop 0
    buffer_load_dwordx4 v4, s[48:51], s79 offen offset:0 lds
    v_mov_b32 v52, 0
    v_mov_b32 v53, 0
    buffer_load_dwordx4 v5, s[48:51], s79 offen offset:1024 lds
    v_mov_b32 v54, 0
    v_mov_b32 v55, 0
    buffer_load_dwordx4 v6, s[48:51], s79 offen offset:2048 lds
    v_mov_b32 v56, 0
    v_mov_b32 v57, 0
    s_add_u32 m0, s81, 151520
    s_nop 0
    buffer_load_dwordx4 v4, s[52:55], s79 offen offset:0 lds
    v_mov_b32 v58, 0
    v_mov_b32 v59, 0
    buffer_load_dwordx4 v5, s[52:55], s79 offen offset:1024 lds
    v_mov_b32 v60, 0
    v_mov_b32 v61, 0
    buffer_load_dwordx4 v6, s[52:55], s79 offen offset:2048 lds
    v_mov_b32 v62, 0
    v_mov_b32 v63, 0
    s_waitcnt lgkmcnt(0) vmcnt(15)
    s_barrier
    s_mov_b32 s82, 4096
    buffer_load_dwordx4 v[20:23], v12, s[60:63], s82 offen sc1
    s_lshl_b32 s76, s70, 10
    s_lshl_b32 s77, s76, 3
    s_lshl_b32 s78, s92, 7
    s_add_u32 s77, s77, s78
    s_waitcnt vmcnt(11)
    s_mov_b32 s94, 20000
L_chk_15:
    v_xor_b32 v16, s69, v101
    v_xor_b32 v17, s69, v106
    v_or_b32 v16, v16, v17
    v_xor_b32 v17, s69, v110
    v_or_b32 v16, v16, v17
    v_xor_b32 v17, s69, v114
    v_or_b32 v16, v16, v17
    v_xor_b32 v17, s69, v118
    v_or_b32 v16, v16, v17
    v_cmp_ne_u32 vcc, 0, v16
    s_nop 1
    s_cbranch_vccz L_ok_16
    s_sub_u32 s94, s94, 1
    s_cbranch_scc1 L_ok_16
    s_sleep 1
    buffer_load_dwordx2 v[100:101], v93, s[60:63], s13 offen sc1
    buffer_load_dwordx4 v[104:107], v94, s[60:63], s12 offen offset:0 sc1
    buffer_load_dwordx4 v[108:111], v94, s[60:63], s12 offen offset:512 sc1
    buffer_load_dwordx4 v[112:115], v94, s[60:63], s12 offen offset:1024 sc1
    buffer_load_dwordx4 v[116:119], v94, s[60:63], s12 offen offset:1536 sc1
    s_waitcnt vmcnt(0)
    s_branch L_chk_15
L_ok_16:
    s_mov_b32 s15, 0x07060302
    s_add_u32 m0, s76, 40768
    s_add_u32 s78, s77, 0
    buffer_load_dwordx4 v7, s[56:59], s78 offen lds
    v_add_f32 v104, v104, v108
    v_add_f32 v112, v112, v116
    v_add_f32 v105, v105, v109
    v_add_f32 v113, v113, v117
    s_add_u32 m0, s76, 44864
    s_add_u32 s78, s77, 32768
    buffer_load_dwordx4 v7, s[56:59], s78 offen lds
    v_and_b32 v120, 0xffff0000, v100
    v_rcp_f32 v121, v120
    v_add_f32 v104, v104, v112
    v_add_f32 v105, v105, v113
    v_and_b32 v127, 0xffff, v100
    s_add_u32 m0, s76, 48960
    s_add_u32 s78, s77, 65536
    buffer_load_dwordx4 v7, s[56:59], s78 offen lds
    v_lshl_or_b32 v127, v100, 16, v127
    v_mul_f32 v126, v120, v120
    v_mul_f32 v124, 0xc0135761, v121
    v_mul_f32 v125, v121, v121
    s_add_u32 m0, s76, 53056
    s_add_u32 s78, s77, 98304
    buffer_load_dwordx4 v7, s[56:59], s78 offen lds
    v_mul_f32 v125, v125, v121
    v_mul_f32 v125, 0xbdd2d3e8, v125
    v_and_b32 v108, 0xffff0000, v104
    v_sub_f32 v108, v104, v108
    v_and_b32 v109, 0xffff0000, v108
    s_add_u32 m0, s76, 57152
    s_add_u32 s78, s77, 131072
    buffer_load_dwordx4 v7, s[56:59], s78 offen lds
    v_sub_f32 v109, v108, v109
    v_perm_b32 v112, v108, v104, s15
    v_lshrrev_b32 v113, 16, v109
    v_and_b32 v108, 0xffff0000, v105
    s_add_u32 m0, s76, 61248
    s_add_u32 s78, s77, 163840
    buffer_load_dwordx4 v7, s[56:59], s78 offen lds
    v_sub_f32 v108, v105, v108
    v_and_b32 v109, 0xffff0000, v108
    v_sub_f32 v109, v108, v109
    v_perm_b32 v114, v108, v105, s15
    v_lshrrev_b32 v115, 16, v109
    s_add_u32 m0, s76, 65344
    s_add_u32 s78, s77, 196608
    buffer_load_dwordx4 v7, s[56:59], s78 offen lds
    s_lshl_b32 s74, s70, 9
    v_add_u32 v16, s74, v95
    v_lshl_add_u32 v17, v1, 3, s74
    s_lshl_b32 s74, s89, 9
    s_add_u32 m0, s76, 69440
    s_add_u32 s78, s77, 229376
    buffer_load_dwordx4 v7, s[56:59], s78 offen lds
    v_lshl_add_u32 v18, v1, 3, s74
    ds_write_b128 v16, v[124:127] offset:0
    ds_write_b64 v17, v[112:113] offset:16896
    ds_write_b64 v18, v[114:115] offset:18944
    s_waitcnt lgkmcnt(0)
    v_mov_b32 v16, s100
    v_mov_b32 v17, 1
    ds_write_b32 v16, v17 offset:21200
    s_waitcnt vmcnt(9)
    s_barrier
    s_waitcnt vmcnt(8)
    s_mov_b32 s94, 20000
L_chk_17:
    v_xor_b32 v24, s69, v20
    v_xor_b32 v25, s69, v21
    v_or_b32 v24, v24, v25
    v_xor_b32 v25, s69, v22
    v_or_b32 v24, v24, v25
    v_xor_b32 v25, s69, v23
    v_or_b32 v24, v24, v25
    v_cmp_ne_u32 vcc, 0, v24
    s_nop 1
    s_cbranch_vccz L_ok_18
    s_sub_u32 s94, s94, 1
    s_cbranch_scc1 L_ok_18
    s_sleep 1
    buffer_load_dwordx4 v[20:23], v12, s[60:63], s82 offen sc1
    s_waitcnt vmcnt(0)
    s_branch L_chk_17
L_ok_18:
    s_lshl_b32 s74, s70, 19
    s_lshl_b32 s75, s93, 5
    s_add_u32 s74, s74, s75
    s_add_u32 s74, s74, 1048576
    s_add_u32 s75, s74, 0x40000
    buffer_load_dwordx4 v[20:23], v90, s[60:63], s74 offen sc1
    buffer_load_dwordx4 v[24:27], v90, s[60:63], s75 offen sc1
    s_or_b32 s74, s2, s70
    s_cmp_eq_u32 s74, 0
    s_cselect_b32 s74, 0, 0x7ffffff0
    v_mov_b32 v16, s69
    s_mov_b64 exec, 1
    buffer_store_dword v16, off, s[60:63], s74 sc1
    s_mov_b64 exec, -1
    s_add_u32 m0, s76, 73536
    s_add_u32 s78, s77, 262144
    buffer_load_dwordx4 v7, s[56:59], s78 offen lds
    s_add_u32 m0, s76, 77632
    s_add_u32 s78, s77, 294912
    buffer_load_dwordx4 v7, s[56:59], s78 offen lds
    s_add_u32 m0, s76, 81728
    s_add_u32 s78, s77, 327680
    buffer_load_dwordx4 v7, s[56:59], s78 offen lds
    s_add_u32 m0, s76, 85824
    s_add_u32 s78, s77, 360448
    buffer_load_dwordx4 v7, s[56:59], s78 offen lds
    ds_write_b128 v87, v[64:67]
    ds_write_b128 v87, v[68:71] offset:16
    ds_write_b128 v88, v[72:75] offset:2048
    ds_write_b64 v89, v[76:77] offset:3072
    ds_write_b64 v89, v[78:79] offset:3584
    ds_write_b64 v89, v[80:81] offset:4096
    s_add_u32 m0, s76, 89920
    s_add_u32 s78, s77, 393216
    buffer_load_dwordx4 v7, s[56:59], s78 offen lds
    s_add_u32 m0, s76, 94016
    s_add_u32 s78, s77, 425984
    buffer_load_dwordx4 v7, s[56:59], s78 offen lds
    s_add_u32 m0, s76, 98112
    s_add_u32 s78, s77, 458752
    buffer_load_dwordx4 v7, s[56:59], s78 offen lds
    s_add_u32 m0, s76, 102208
    s_add_u32 s78, s77, 491520
    buffer_load_dwordx4 v7, s[56:59], s78 offen lds
    s_add_u32 m0, s76, 106304
    s_add_u32 s78, s77, 524288
    buffer_load_dwordx4 v7, s[56:59], s78 offen lds
    s_add_u32 m0, s76, 110400
    s_add_u32 s78, s77, 557056
    buffer_load_dwordx4 v7, s[56:59], s78 offen lds
    s_add_u32 m0, s76, 114496
    s_add_u32 s78, s77, 589824
    buffer_load_dwordx4 v7, s[56:59], s78 offen lds
    s_add_u32 m0, s76, 118592
    s_add_u32 s78, s77, 622592
    buffer_load_dwordx4 v7, s[56:59], s78 offen lds
    s_waitcnt vmcnt(8)
    v_mov_b32 v16, s100
    v_mov_b32 v17, 1
    ds_write_b32 v16, v17 offset:21024
    v_mov_b32 v104, 0
    s_mov_b32 s94, 0x400000
L_lw_19:
    ds_read_b128 v[106:109], v104 offset:21152
    s_waitcnt lgkmcnt(0)
    v_and_b32 v106, v106, v107
    v_and_b32 v108, v108, v109
    v_and_b32 v106, v106, v108
    s_nop 0
    v_readfirstlane_b32 s95, v106
    s_nop 0
    s_cmp_lg_u32 s95, 0
    s_cbranch_scc1 L_lwd_20
    s_sleep 1
    s_sub_u32 s94, s94, 1
    s_cbranch_scc0 L_lw_19
L_lwd_20:
    s_setprio 2
    s_add_u32 m0, s76, 122688
    s_add_u32 s78, s77, 655360
    buffer_load_dwordx4 v7, s[56:59], s78 offen lds
    s_add_u32 m0, s76, 126784
    s_add_u32 s78, s77, 688128
    buffer_load_dwordx4 v7, s[56:59], s78 offen lds
    s_add_u32 m0, s76, 130880
    s_add_u32 s78, s77, 720896
    buffer_load_dwordx4 v7, s[56:59], s78 offen lds
    s_add_u32 m0, s76, 134976
    s_add_u32 s78, s77, 753664
    buffer_load_dwordx4 v7, s[56:59], s78 offen lds
    s_add_u32 m0, s76, 139072
    s_add_u32 s78, s77, 786432
    buffer_load_dwordx4 v7, s[56:59], s78 offen lds
    ds_write_b32 v92, v80
    ds_write_b128 v91, v[20:23] offset:64
    v_mov_b32 v96, v21
    v_mov_b32 v97, v22
    v_mov_b32 v98, v23
    ds_write_b32 v91, v20 offset:4284
    ds_write_b96 v91, v[96:98] offset:4288
    ds_write_b128 v91, v[24:27] offset:576
    v_mov_b32 v100, v25
    v_mov_b32 v101, v26
    v_mov_b32 v102, v27
    ds_write_b32 v91, v24 offset:4796
    ds_write_b96 v91, v[100:102] offset:4800
    s_add_u32 m0, s76, 143168
    s_add_u32 s78, s77, 819200
    buffer_load_dwordx4 v7, s[56:59], s78 offen lds
    s_add_u32 m0, s76, 147264
    s_add_u32 s78, s77, 851968
    buffer_load_dwordx4 v7, s[56:59], s78 offen lds
    s_add_u32 m0, s76, 151360
    s_add_u32 s78, s77, 884736
    buffer_load_dwordx4 v7, s[56:59], s78 offen lds
    s_add_u32 m0, s76, 155456
    s_add_u32 s78, s77, 917504
    buffer_load_dwordx4 v7, s[56:59], s78 offen lds
    s_add_u32 m0, s76, 159552
    s_add_u32 s78, s77, 950272
    buffer_load_dwordx4 v7, s[56:59], s78 offen lds
    s_add_u32 m0, s76, 16896
    s_add_u32 s78, s77, 1376256
    buffer_load_dwordx4 v7, s[56:59], s78 offen lds
    s_waitcnt lgkmcnt(0)
    v_mov_b32 v16, s100
    v_mov_b32 v17, 1
    ds_write_b32 v16, v17 offset:21056
    v_mov_b32 v16, 0
    s_mov_b32 s94, 0x400000
L_lw_21:
    ds_read_b128 v[18:21], v16 offset:21056
    s_waitcnt lgkmcnt(0)
    v_and_b32 v18, v18, v19
    v_and_b32 v20, v20, v21
    v_and_b32 v18, v18, v20
    s_nop 0
    v_readfirstlane_b32 s95, v18
    s_nop 0
    s_cmp_lg_u32 s95, 0
    s_cbranch_scc1 L_lwd_22
    s_sleep 1
    s_sub_u32 s94, s94, 1
    s_cbranch_scc0 L_lw_21
L_lwd_22:
    ds_read_b128 v[64:67], v8 offset:3584
    ds_read_b64 v[96:97], v9 offset:0
    ds_read_b64 v[98:99], v9 offset:8
    ds_read_b128 v[68:71], v8 offset:3072
    ds_read_b64 v[100:101], v9 offset:512
    ds_read_b64 v[102:103], v9 offset:520
    ds_read_b128 v[72:75], v8 offset:2560
    ds_read_b64 v[104:105], v9 offset:1024
    ds_read_b64 v[106:107], v9 offset:1032
    ds_read_b128 v[76:79], v8 offset:2048
    ds_read_b64 v[108:109], v9 offset:1536
    ds_read_b64 v[110:111], v9 offset:1544
    ds_read_b128 v[80:83], v8 offset:1536
    ds_read_b64 v[112:113], v9 offset:2048
    ds_read_b64 v[114:115], v9 offset:2056
    ds_read_b128 v[84:87], v8 offset:1024
    ds_read_b64 v[116:117], v9 offset:2560
    ds_read_b64 v[118:119], v9 offset:2568
    ds_read_b128 v[88:91], v8 offset:512
    ds_read_b64 v[120:121], v9 offset:3072
    ds_read_b64 v[122:123], v9 offset:3080
    ds_read_b128 v[92:95], v8 offset:0
    ds_read_b64 v[124:125], v9 offset:3584
    ds_read_b64 v[126:127], v9 offset:3592
    v_mov_b32 v16, 0
    s_mov_b32 s94, 0x400000
L_lw_23:
    ds_read_b128 v[18:21], v16 offset:21088
    s_waitcnt lgkmcnt(0)
    v_and_b32 v18, v18, v19
    v_and_b32 v20, v20, v21
    v_and_b32 v18, v18, v20
    s_nop 0
    v_readfirstlane_b32 s95, v18
    s_nop 0
    s_cmp_lg_u32 s95, 0
    s_cbranch_scc1 L_lwd_24
    s_sleep 1
    s_sub_u32 s94, s94, 1
    s_cbranch_scc0 L_lw_23
L_lwd_24:
    s_mov_b32 s79, 0
L_cv:
    s_waitcnt lgkmcnt(0)
    v_mfma_f32_16x16x32_bf16 v[32:35], v[64:67], v[96:99], v[32:35]
    ds_read_b128 v[128:131], v8 offset:3648
    v_mfma_f32_16x16x32_bf16 v[36:39], v[68:71], v[96:99], v[36:39]
    ds_read_b64 v[160:161], v9 offset:64
    v_mfma_f32_16x16x32_bf16 v[40:43], v[72:75], v[96:99], v[40:43]
    ds_read_b64 v[162:163], v9 offset:72
    v_mfma_f32_16x16x32_bf16 v[44:47], v[76:79], v[96:99], v[44:47]
    ds_read_b128 v[132:135], v8 offset:3136
    v_mfma_f32_16x16x32_bf16 v[48:51], v[80:83], v[96:99], v[48:51]
    ds_read_b64 v[164:165], v9 offset:576
    v_mfma_f32_16x16x32_bf16 v[52:55], v[84:87], v[96:99], v[52:55]
    ds_read_b64 v[166:167], v9 offset:584
    v_mfma_f32_16x16x32_bf16 v[56:59], v[88:91], v[96:99], v[56:59]
    ds_read_b128 v[136:139], v8 offset:2624
    v_mfma_f32_16x16x32_bf16 v[60:63], v[92:95], v[96:99], v[60:63]
    ds_read_b64 v[168:169], v9 offset:1088
    v_mfma_f32_16x16x32_bf16 v[36:39], v[64:67], v[100:103], v[36:39]
    ds_read_b64 v[170:171], v9 offset:1096
    v_mfma_f32_16x16x32_bf16 v[40:43], v[68:71], v[100:103], v[40:43]
    ds_read_b128 v[140:143], v8 offset:2112
    v_mfma_f32_16x16x32_bf16 v[44:47], v[72:75], v[100:103], v[44:47]
    ds_read_b64 v[172:173], v9 offset:1600
    v_mfma_f32_16x16x32_bf16 v[48:51], v[76:79], v[100:103], v[48:51]
    ds_read_b64 v[174:175], v9 offset:1608
    v_mfma_f32_16x16x32_bf16 v[52:55], v[80:83], v[100:103], v[52:55]
    ds_read_b128 v[144:147], v8 offset:1600
    v_mfma_f32_16x16x32_bf16 v[56:59], v[84:87], v[100:103], v[56:59]
    ds_read_b64 v[176:177], v9 offset:2112
    v_mfma_f32_16x16x32_bf16 v[60:63], v[88:91], v[100:103], v[60:63]
    ds_read_b64 v[178:179], v9 offset:2120
    v_mfma_f32_16x16x32_bf16 v[40:43], v[64:67], v[104:107], v[40:43]
    ds_read_b128 v[148:151], v8 offset:1088
    v_mfma_f32_16x16x32_bf16 v[44:47], v[68:71], v[104:107], v[44:47]
    ds_read_b64 v[180:181], v9 offset:2624
    v_mfma_f32_16x16x32_bf16 v[48:51], v[72:75], v[104:107], v[48:51]
    ds_read_b64 v[182:183], v9 offset:2632
    v_mfma_f32_16x16x32_bf16 v[52:55], v[76:79], v[104:107], v[52:55]
    ds_read_b128 v[152:155], v8 offset:576
    v_mfma_f32_16x16x32_bf16 v[56:59], v[80:83], v[104:107], v[56:59]
    ds_read_b64 v[184:185], v9 offset:3136
    v_mfma_f32_16x16x32_bf16 v[60:63], v[84:87], v[104:107], v[60:63]
    ds_read_b64 v[186:187], v9 offset:3144
    v_mfma_f32_16x16x32_bf16 v[44:47], v[64:67], v[108:111], v[44:47]
    ds_read_b128 v[156:159], v8 offset:64
    v_mfma_f32_16x16x32_bf16 v[48:51], v[68:71], v[108:111], v[48:51]
    ds_read_b64 v[188:189], v9 offset:3648
    v_mfma_f32_16x16x32_bf16 v[52:55], v[72:75], v[108:111], v[52:55]
    ds_read_b64 v[190:191], v9 offset:3656
    v_mfma_f32_16x16x32_bf16 v[56:59], v[76:79], v[108:111], v[56:59]
    v_mfma_f32_16x16x32_bf16 v[60:63], v[80:83], v[108:111], v[60:63]
    v_mfma_f32_16x16x32_bf16 v[48:51], v[64:67], v[112:115], v[48:51]
    v_mfma_f32_16x16x32_bf16 v[52:55], v[68:71], v[112:115], v[52:55]
    v_mfma_f32_16x16x32_bf16 v[56:59], v[72:75], v[112:115], v[56:59]
    v_mfma_f32_16x16x32_bf16 v[60:63], v[76:79], v[112:115], v[60:63]
    v_mfma_f32_16x16x32_bf16 v[52:55], v[64:67], v[116:119], v[52:55]
    v_mfma_f32_16x16x32_bf16 v[56:59], v[68:71], v[116:119], v[56:59]
    v_mfma_f32_16x16x32_bf16 v[60:63], v[72:75], v[116:119], v[60:63]
    v_mfma_f32_16x16x32_bf16 v[56:59], v[64:67], v[120:123], v[56:59]
    v_mfma_f32_16x16x32_bf16 v[60:63], v[68:71], v[120:123], v[60:63]
    v_mfma_f32_16x16x32_bf16 v[60:63], v[64:67], v[124:127], v[60:63]
    s_waitcnt lgkmcnt(0)
    v_mfma_f32_16x16x32_bf16 v[32:35], v[128:131], v[160:163], v[32:35]
    ds_read_b128 v[64:67], v8 offset:3712
    v_mfma_f32_16x16x32_bf16 v[36:39], v[132:135], v[160:163], v[36:39]
    ds_read_b64 v[96:97], v9 offset:128
    v_mfma_f32_16x16x32_bf16 v[40:43], v[136:139], v[160:163], v[40:43]
    ds_read_b64 v[98:99], v9 offset:136
    v_mfma_f32_16x16x32_bf16 v[44:47], v[140:143], v[160:163], v[44:47]
    ds_read_b128 v[68:71], v8 offset:3200
    v_mfma_f32_16x16x32_bf16 v[48:51], v[144:147], v[160:163], v[48:51]
    ds_read_b64 v[100:101], v9 offset:640
    v_mfma_f32_16x16x32_bf16 v[52:55], v[148:151], v[160:163], v[52:55]
    ds_read_b64 v[102:103], v9 offset:648
    v_mfma_f32_16x16x32_bf16 v[56:59], v[152:155], v[160:163], v[56:59]
    ds_read_b128 v[72:75], v8 offset:2688
    v_mfma_f32_16x16x32_bf16 v[60:63], v[156:159], v[160:163], v[60:63]
    ds_read_b64 v[104:105], v9 offset:1152
    v_mfma_f32_16x16x32_bf16 v[36:39], v[128:131], v[164:167], v[36:39]
    ds_read_b64 v[106:107], v9 offset:1160
    v_mfma_f32_16x16x32_bf16 v[40:43], v[132:135], v[164:167], v[40:43]
    ds_read_b128 v[76:79], v8 offset:2176
    v_mfma_f32_16x16x32_bf16 v[44:47], v[136:139], v[164:167], v[44:47]
    ds_read_b64 v[108:109], v9 offset:1664
    v_mfma_f32_16x16x32_bf16 v[48:51], v[140:143], v[164:167], v[48:51]
    ds_read_b64 v[110:111], v9 offset:1672
    v_mfma_f32_16x16x32_bf16 v[52:55], v[144:147], v[164:167], v[52:55]
    ds_read_b128 v[80:83], v8 offset:1664
    v_mfma_f32_16x16x32_bf16 v[56:59], v[148:151], v[164:167], v[56:59]
    ds_read_b64 v[112:113], v9 offset:2176
    v_mfma_f32_16x16x32_bf16 v[60:63], v[152:155], v[164:167], v[60:63]
    ds_read_b64 v[114:115], v9 offset:2184
    v_mfma_f32_16x16x32_bf16 v[40:43], v[128:131], v[168:171], v[40:43]
    ds_read_b128 v[84:87], v8 offset:1152
    v_mfma_f32_16x16x32_bf16 v[44:47], v[132:135], v[168:171], v[44:47]
    ds_read_b64 v[116:117], v9 offset:2688
    v_mfma_f32_16x16x32_bf16 v[48:51], v[136:139], v[168:171], v[48:51]
    ds_read_b64 v[118:119], v9 offset:2696
    v_mfma_f32_16x16x32_bf16 v[52:55], v[140:143], v[168:171], v[52:55]
    ds_read_b128 v[88:91], v8 offset:640
    v_mfma_f32_16x16x32_bf16 v[56:59], v[144:147], v[168:171], v[56:59]
    ds_read_b64 v[120:121], v9 offset:3200
    v_mfma_f32_16x16x32_bf16 v[60:63], v[148:151], v[168:171], v[60:63]
    ds_read_b64 v[122:123], v9 offset:3208
    v_mfma_f32_16x16x32_bf16 v[44:47], v[128:131], v[172:175], v[44:47]
    ds_read_b128 v[92:95], v8 offset:128
    v_mfma_f32_16x16x32_bf16 v[48:51], v[132:135], v[172:175], v[48:51]
    ds_read_b64 v[124:125], v9 offset:3712
    v_mfma_f32_16x16x32_bf16 v[52:55], v[136:139], v[172:175], v[52:55]
    ds_read_b64 v[126:127], v9 offset:3720
    v_mfma_f32_16x16x32_bf16 v[56:59], v[140:143], v[172:175], v[56:59]
    v_add_u32 v8, 128, v8
    v_mfma_f32_16x16x32_bf16 v[60:63], v[144:147], v[172:175], v[60:63]
    v_add_u32 v9, 128, v9
    v_mfma_f32_16x16x32_bf16 v[48:51], v[128:131], v[176:179], v[48:51]
    v_mfma_f32_16x16x32_bf16 v[52:55], v[132:135], v[176:179], v[52:55]
    v_mfma_f32_16x16x32_bf16 v[56:59], v[136:139], v[176:179], v[56:59]
    v_mfma_f32_16x16x32_bf16 v[60:63], v[140:143], v[176:179], v[60:63]
    v_mfma_f32_16x16x32_bf16 v[52:55], v[128:131], v[180:183], v[52:55]
    v_mfma_f32_16x16x32_bf16 v[56:59], v[132:135], v[180:183], v[56:59]
    v_mfma_f32_16x16x32_bf16 v[60:63], v[136:139], v[180:183], v[60:63]
    v_mfma_f32_16x16x32_bf16 v[56:59], v[128:131], v[184:187], v[56:59]
    v_mfma_f32_16x16x32_bf16 v[60:63], v[132:135], v[184:187], v[60:63]
    v_mfma_f32_16x16x32_bf16 v[60:63], v[128:131], v[188:191], v[60:63]
    s_waitcnt vmcnt(0)
    v_mov_b32 v16, s100
    v_mov_b32 v17, 1
    ds_write_b32 v16, v17 offset:21104
    s_add_u32 s79, s79, 1
    s_cmp_lt_u32 s79, 2
    s_cbranch_scc1 L_cv
    s_waitcnt lgkmcnt(0)
    v_mov_b32 v18, s100
    v_mov_b32 v19, 1
    ds_write_b32 v18, v19 offset:21072
    s_lshl_b32 s74, s70, 12
    s_add_u32 s74, s74, 22208
    v_add_u32 v24, s74, v12
    v_xor_b32 v25, 4096, v12
    s_xor_b32 s75, s70, 1
    s_lshl_b32 s75, s75, 12
    s_add_u32 s75, s75, 22208
    v_add_u32 v25, s75, v12
    v_mov_b32 v18, 0
    s_mov_b32 s94, 0x400000
L_lw_25:
    ds_read_b128 v[20:23], v18 offset:21072
    s_waitcnt lgkmcnt(0)
    v_and_b32 v20, v20, v21
    v_and_b32 v22, v22, v23
    v_and_b32 v20, v20, v22
    s_nop 0
    v_readfirstlane_b32 s95, v20
    s_nop 0
    s_cmp_lg_u32 s95, 0
    s_cbranch_scc1 L_lwd_26
    s_sleep 1
    s_sub_u32 s94, s94, 1
    s_cbranch_scc0 L_lw_25
L_lwd_26:
    s_cmp_eq_u32 s89, 0
    s_cbranch_scc1 L_rlo_27
    ds_write_b128 v24, v[32:35] offset:0
    ds_write_b128 v24, v[36:39] offset:1024
    ds_write_b128 v24, v[40:43] offset:2048
    ds_write_b128 v24, v[44:47] offset:3072
    s_waitcnt lgkmcnt(0)
    v_mov_b32 v32, v48
    v_mov_b32 v33, v49
    v_mov_b32 v34, v50
    v_mov_b32 v35, v51
    v_mov_b32 v36, v52
    v_mov_b32 v37, v53
    v_mov_b32 v38, v54
    v_mov_b32 v39, v55
    v_mov_b32 v40, v56
    v_mov_b32 v41, v57
    v_mov_b32 v42, v58
    v_mov_b32 v43, v59
    v_mov_b32 v44, v60
    v_mov_b32 v45, v61
    v_mov_b32 v46, v62
    v_mov_b32 v47, v63
    s_branch L_rdn_28
L_rlo_27:
    ds_write_b128 v24, v[48:51] offset:0
    ds_write_b128 v24, v[52:55] offset:1024
    ds_write_b128 v24, v[56:59] offset:2048
    ds_write_b128 v24, v[60:63] offset:3072
L_rdn_28:
    s_waitcnt lgkmcnt(0)
    v_mov_b32 v18, s100
    v_mov_b32 v19, 1
    ds_write_b32 v18, v19 offset:21008
    v_mov_b32 v18, 0
    s_mov_b32 s94, 0x400000
L_lw_29:
    ds_read_b128 v[20:23], v18 offset:21008
    s_waitcnt lgkmcnt(0)
    v_and_b32 v20, v20, v21
    v_and_b32 v22, v22, v23
    v_and_b32 v20, v20, v22
    s_nop 0
    v_readfirstlane_b32 s95, v20
    s_nop 0
    s_cmp_lg_u32 s95, 0
    s_cbranch_scc1 L_lwd_30
    s_sleep 1
    s_sub_u32 s94, s94, 1
    s_cbranch_scc0 L_lw_29
L_lwd_30:
    ds_read_b128 v[64:67], v25 offset:0
    ds_read_b128 v[68:71], v25 offset:1024
    ds_read_b128 v[72:75], v25 offset:2048
    ds_read_b128 v[76:79], v25 offset:3072
    v_lshrrev_b32 v16, 4, v1
    v_lshlrev_b32 v16, 17, v16
    v_and_b32 v17, 15, v1
    v_lshl_add_u32 v16, v17, 4, v16
    s_lshl_b32 s74, s93, 1
    s_add_u32 s74, s74, s88
    s_lshl_b32 s74, s74, 8
    s_lshl_b32 s75, s89, 21
    s_add_u32 s74, s74, s75
    s_add_u32 s74, s74, 3145728
    v_mov_b32 v50, s69
    v_mov_b32 v51, s69
    v_mov_b32 v54, s69
    v_mov_b32 v55, s69
    v_mov_b32 v58, s69
    v_mov_b32 v59, s69
    v_mov_b32 v62, s69
    v_mov_b32 v63, s69
    s_waitcnt lgkmcnt(0)
    v_pk_add_f32 v[32:33], v[32:33], v[64:65]
    v_pk_add_f32 v[34:35], v[34:35], v[66:67]
    v_pk_add_f32 v[36:37], v[36:37], v[68:69]
    v_pk_add_f32 v[38:39], v[38:39], v[70:71]
    v_pk_add_f32 v[40:41], v[40:41], v[72:73]
    v_pk_add_f32 v[42:43], v[42:43], v[74:75]
    v_pk_add_f32 v[44:45], v[44:45], v[76:77]
    v_pk_add_f32 v[46:47], v[46:47], v[78:79]
    v_cvt_pk_bf16_f32 v48, v32, v33
    v_cvt_pk_bf16_f32 v49, v34, v35
    buffer_store_dwordx4 v[48:51], v16, s[60:63], s74 offen sc1
    v_cvt_pk_bf16_f32 v52, v36, v37
    v_cvt_pk_bf16_f32 v53, v38, v39
    s_add_u32 s74, s74, 0x80000
    buffer_store_dwordx4 v[52:55], v16, s[60:63], s74 offen sc1
    v_cvt_pk_bf16_f32 v56, v40, v41
    v_cvt_pk_bf16_f32 v57, v42, v43
    s_add_u32 s74, s74, 0x80000
    buffer_store_dwordx4 v[56:59], v16, s[60:63], s74 offen sc1
    v_cvt_pk_bf16_f32 v60, v44, v45
    v_cvt_pk_bf16_f32 v61, v46, v47
    s_add_u32 s74, s74, 0x80000
    buffer_store_dwordx4 v[60:63], v16, s[60:63], s74 offen sc1
    v_lshrrev_b32 v132, 3, v0
    v_and_b32 v133, 7, v0
    v_lshlrev_b32 v133, 4, v133
    v_lshl_add_u32 v132, v132, 10, v133
    s_lshl_b32 s74, s91, 16
    s_lshl_b32 s75, s92, 7
    s_add_u32 s74, s74, s75
    v_add_u32 v132, s74, v132
    global_load_dwordx4 v[128:131], v132, s[16:17]
    s_waitcnt vmcnt(0)
    v_mov_b32 v16, s100
    v_mov_b32 v17, 1
    ds_write_b32 v16, v17 offset:21168
    v_mov_b32 v16, 0
    s_mov_b32 s94, 0x400000
L_lw_31:
    ds_read_b128 v[18:21], v16 offset:21136
    s_waitcnt lgkmcnt(0)
    v_and_b32 v18, v18, v19
    v_and_b32 v20, v20, v21
    v_and_b32 v18, v18, v20
    s_nop 0
    v_readfirstlane_b32 s95, v18
    s_nop 0
    s_cmp_lg_u32 s95, 0
    s_cbranch_scc1 L_lwd_32
    s_sleep 1
    s_sub_u32 s94, s94, 1
    s_cbranch_scc0 L_lw_31
L_lwd_32:
    s_lshl_b32 s74, s91, 17
    s_lshl_b32 s75, s92, 14
    s_add_u32 s74, s74, s75
    s_lshl_b32 s75, s70, 12
    s_add_u32 s74, s74, s75
    s_add_u32 s82, s74, 3145728
    buffer_load_dwordx4 v[64:67], v12, s[60:63], s82 offen offset:0 sc1
    buffer_load_dwordx4 v[68:71], v12, s[60:63], s82 offen offset:1024 sc1
    buffer_load_dwordx4 v[72:75], v12, s[60:63], s82 offen offset:2048 sc1
    buffer_load_dwordx4 v[76:79], v12, s[60:63], s82 offen offset:3072 sc1
    s_lshl_b32 s75, s70, 11
    v_lshrrev_b32 v16, 4, v1
    v_lshlrev_b32 v16, 7, v16
    v_and_b32 v17, 15, v1
    v_lshl_add_u32 v16, v17, 2, v16
    v_add_u32 v16, s75, v16
    v_add_u32 v16, 0, v16
    v_add_u32 v17, 1024, v16
    s_waitcnt vmcnt(0)
    s_mov_b32 s94, 20000
L_chk_33:
    v_xor_b32 v18, s69, v66
    v_xor_b32 v19, s69, v70
    v_or_b32 v18, v18, v19
    v_xor_b32 v19, s69, v74
    v_or_b32 v18, v18, v19
    v_xor_b32 v19, s69, v78
    v_or_b32 v18, v18, v19
    v_cmp_ne_u32 vcc, 0, v18
    s_nop 1
    s_cbranch_vccz L_ok_34
    s_sub_u32 s94, s94, 1
    s_cbranch_scc1 L_ok_34
    s_sleep 1
    buffer_load_dwordx4 v[64:67], v12, s[60:63], s82 offen offset:0 sc1
    buffer_load_dwordx4 v[68:71], v12, s[60:63], s82 offen offset:1024 sc1
    buffer_load_dwordx4 v[72:75], v12, s[60:63], s82 offen offset:2048 sc1
    buffer_load_dwordx4 v[76:79], v12, s[60:63], s82 offen offset:3072 sc1
    s_waitcnt vmcnt(0)
    s_branch L_chk_33
L_ok_34:
    ds_write2_b32 v16, v64, v65 offset0:0 offset1:16
    ds_write2_b32 v16, v68, v69 offset0:128 offset1:144
    ds_write2_b32 v17, v72, v73 offset0:0 offset1:16
    ds_write2_b32 v17, v76, v77 offset0:128 offset1:144
    v_bfe_u32 v14, v1, 2, 2
    v_lshlrev_b32 v14, 7, v14
    v_lshrrev_b32 v15, 4, v1
    v_lshl_add_u32 v14, v15, 5, v14
    v_and_b32 v15, 3, v1
    v_lshl_add_u32 v14, v15, 3, v14
    s_add_u32 s75, s75, 0
    v_add_u32 v14, s75, v14
    v_mul_u32_u24 v15, 272, v1
    s_lshl_b32 s75, s70, 6
    s_add_u32 s75, s75, 22208
    v_add_u32 v15, s75, v15
    s_waitcnt lgkmcnt(0)
    ds_read_b64_tr_b16 v[20:21], v14 offset:0
    ds_read_b64_tr_b16 v[22:23], v14 offset:512
    ds_read_b64_tr_b16 v[24:25], v14 offset:1024
    ds_read_b64_tr_b16 v[26:27], v14 offset:1536
    v_mov_b32 v40, 0
    s_mov_b32 s94, 0x400000
L_lw_35:
    ds_read_b128 v[42:45], v40 offset:21168
    s_waitcnt lgkmcnt(0)
    v_and_b32 v42, v42, v43
    v_and_b32 v44, v44, v45
    v_and_b32 v42, v42, v44
    s_nop 0
    v_readfirstlane_b32 s95, v42
    s_nop 0
    s_cmp_lg_u32 s95, 0
    s_cbranch_scc1 L_lwd_36
    s_sleep 1
    s_sub_u32 s94, s94, 1
    s_cbranch_scc0 L_lw_35
L_lwd_36:
    v_lshlrev_b32 v32, 16, v20
    v_and_b32 v33, 0xffff0000, v20
    v_lshlrev_b32 v34, 16, v21
    v_and_b32 v35, 0xffff0000, v21
    v_lshlrev_b32 v36, 16, v22
    v_and_b32 v37, 0xffff0000, v22
    v_lshlrev_b32 v38, 16, v23
    v_and_b32 v39, 0xffff0000, v23
    v_lshlrev_b32 v40, 16, v24
    v_and_b32 v41, 0xffff0000, v24
    v_lshlrev_b32 v42, 16, v25
    v_and_b32 v43, 0xffff0000, v25
    v_lshlrev_b32 v44, 16, v26
    v_and_b32 v45, 0xffff0000, v26
    v_lshlrev_b32 v46, 16, v27
    v_and_b32 v47, 0xffff0000, v27
    ds_write_b128 v15, v[32:35] offset:0
    ds_write_b128 v15, v[36:39] offset:16
    ds_write_b128 v15, v[40:43] offset:32
    ds_write_b128 v15, v[44:47] offset:48
    s_waitcnt lgkmcnt(0)
L_final:
    v_lshrrev_b32 v14, 3, v0
    v_mul_u32_u24 v14, 272, v14
    v_and_b32 v15, 7, v0
    v_lshl_add_u32 v14, v15, 5, v14
    v_add_u32 v15, 22208, v14
    v_add_u32 v14, 89920, v14
    v_lshlrev_b32 v32, 16, v128
    v_and_b32 v33, 0xffff0000, v128
    v_lshlrev_b32 v34, 16, v129
    v_and_b32 v35, 0xffff0000, v129
    v_lshlrev_b32 v36, 16, v130
    v_and_b32 v37, 0xffff0000, v130
    v_lshlrev_b32 v38, 16, v131
    v_and_b32 v39, 0xffff0000, v131
    s_barrier
    ds_read_b128 v[16:19], v14
    ds_read_b128 v[20:23], v14 offset:16
    ds_read_b128 v[24:27], v14 offset:17408
    ds_read_b128 v[28:31], v14 offset:17424
    ds_read_b128 v[40:43], v15
    ds_read_b128 v[44:47], v15 offset:16
    s_waitcnt lgkmcnt(2)
    v_pk_add_f32 v[16:17], v[16:17], v[24:25]
    v_pk_add_f32 v[18:19], v[18:19], v[26:27]
    v_pk_add_f32 v[20:21], v[20:21], v[28:29]
    v_pk_add_f32 v[22:23], v[22:23], v[30:31]
    s_waitcnt lgkmcnt(0)
    v_pk_add_f32 v[32:33], v[32:33], v[40:41]
    v_pk_add_f32 v[34:35], v[34:35], v[42:43]
    v_pk_add_f32 v[36:37], v[36:37], v[44:45]
    v_pk_add_f32 v[38:39], v[38:39], v[46:47]
    v_pk_add_f32 v[16:17], v[16:17], v[32:33]
    v_pk_add_f32 v[18:19], v[18:19], v[34:35]
    v_pk_add_f32 v[20:21], v[20:21], v[36:37]
    v_pk_add_f32 v[22:23], v[22:23], v[38:39]
    v_cvt_pk_bf16_f32 v24, v16, v17
    v_cvt_pk_bf16_f32 v25, v18, v19
    v_cvt_pk_bf16_f32 v26, v20, v21
    v_cvt_pk_bf16_f32 v27, v22, v23
    global_store_dwordx4 v132, v[24:27], s[38:39]
L_end:
    s_endpgm
.section .rodata,"a"
.p2align 6
.amdhsa_kernel parallel_sum__ssm_conv_s4d__geglu_ffn__prompt_kernel
  .amdhsa_next_free_vgpr 256
  .amdhsa_next_free_sgpr 102
  .amdhsa_accum_offset 256
  .amdhsa_group_segment_fixed_size 0
  .amdhsa_kernarg_size 112
  .amdhsa_user_sgpr_count 2
  .amdhsa_user_sgpr_kernarg_segment_ptr 1
  .amdhsa_system_sgpr_workgroup_id_x 1
.end_amdhsa_kernel
```
